```python
import torch

def _softmax(x, axis=-1):
    return torch.softmax(x, dim=axis)
def _gelu(x):
    return torch.nn.functional.gelu(x, approximate="tanh")
def _silu(x):
    return torch.nn.functional.silu(x)
def _sigmoid(x):
    return torch.sigmoid(x)
def _layernorm(x, axis=-1, eps=1e-5):
    m = x.mean(dim=axis, keepdim=True)
    v = x.var(dim=axis, keepdim=True, unbiased=False)
    return (x - m) / torch.sqrt(v + eps)
def _scatter_add(tgt, idx, src, axis=0):
    return tgt.clone().index_add_(axis, idx, src)
def _segment_sum(src, seg, n):
    out = torch.zeros((n,) + src.shape[1:], dtype=src.dtype)
    return out.index_add_(0, seg, src)
def _pad(x, pw):
    flat = tuple(v for pair in reversed(pw) for v in pair)
    return torch.nn.functional.pad(x, flat)

kernel_name = 'parallel_sum__ssm_conv_h3__glu_gated_geglu__prompt'

def setup_inputs():

    _w = (lambda a: (lambda t: t.to(torch.bfloat16) if t.is_floating_point() else t)(torch.as_tensor(a)))
    def _A_setup():
        B, S, D = 1, 2048, 576
        ks = 4
        return {
            "q": _w((lambda *s: torch.randn(*s, dtype=torch.bfloat16) * 0.05)(B, S, D)),
            "k": _w((lambda *s: torch.randn(*s, dtype=torch.bfloat16) * 0.2)(B, S, D)),
            "v": _w((lambda *s: torch.randn(*s, dtype=torch.bfloat16) * 0.2)(B, S, D)),
            "shift_k": _w((lambda *s: torch.randn(*s, dtype=torch.bfloat16) * 0.2)(D, ks) * 0.5),
            "ssm_k": _w((lambda *s: torch.randn(*s, dtype=torch.bfloat16) * 0.4)(D, S) * (1.0 / S ** 0.5)),
            "ssm_D": _w((lambda *s: torch.randn(*s, dtype=torch.bfloat16) * 0.2)(D)),
        }
    _A_in = _A_setup()

    def _B_setup():
        B, S, Dm, Df = 1, 2048, 576, 4608
        return {
            "x": _w((lambda *s: torch.randn(*s, dtype=torch.bfloat16) * 0.05)(B, S, Dm)),
            "w_gate": _w((lambda *s: torch.randn(*s, dtype=torch.bfloat16) * 0.4)(Dm, Df) * (Dm ** -0.5)),
            "w_up": _w((lambda *s: torch.randn(*s, dtype=torch.bfloat16) * 0.4)(Dm, Df) * (Dm ** -0.5)),
            "w_down": _w((lambda *s: torch.randn(*s, dtype=torch.bfloat16) * 0.4)(Df, Dm) * (Df ** -0.5)),
        }
    _B_in = _B_setup()

    return {
        "A_q": _A_in["q"],
        "A_k": _A_in["k"],
        "A_v": _A_in["v"],
        "A_shift_k": _A_in["shift_k"],
        "A_ssm_k": _A_in["ssm_k"],
        "A_ssm_D": _A_in["ssm_D"],
        "B_x": _B_in["x"],
        "B_w_gate": _B_in["w_gate"],
        "B_w_up": _B_in["w_up"],
        "B_w_down": _B_in["w_down"],
    }

def reference(A_q, A_k, A_v, A_shift_k, A_ssm_k, A_ssm_D, B_x, B_w_gate, B_w_up, B_w_down):
    def _A_ref(q, k, v, shift_k, ssm_k, ssm_D):
        B, S, D = q.shape
        ks = shift_k.shape[-1]
        k_pad = _pad(k, ((0, 0), (ks - 1, 0), (0, 0)))
        k_shift = torch.zeros_like(k)
        for t in range(ks):
            k_shift = k_shift + k_pad[:, t:t + S, :] * shift_k[:, ks - 1 - t][None, None, :]
        kv = k_shift * v
        L = 2 * S
        kv_pad = _pad(kv, ((0, 0), (0, S), (0, 0)))
        kf_pad = _pad(ssm_k, ((0, 0), (0, S)))
        kv_f = (lambda x, axes=(-2,-1): torch.fft.rfft2(x.float(), dim=axes))(kv_pad[:, None, :, :], axes=(1, 2))
        kf_f = (lambda x, axes=(-2,-1): torch.fft.rfft2(x.float(), dim=axes))(kf_pad[:, None, :], axes=(1, 2))
        kf_f = (lambda x, *d: x.permute(*d))(kf_f, 1, 2, 0)
        y_f = kv_f * kf_f[None, :, :, :]
        y = (lambda x, s, axes=(-2,-1): torch.fft.irfft2(x, s=s, dim=axes).to(torch.bfloat16))(y_f, (1, L), axes=(1, 2))[:, 0, :S, :]
        y = y + kv * ssm_D[None, None, :]
        return q * y

    def _B_ref(x, w_gate, w_up, w_down):
        g = torch.einsum("bsd,df->bsf", x, w_gate)
        u = torch.einsum("bsd,df->bsf", x, w_up)
        h = _gelu(g) * u
        return torch.einsum("bsf,fd->bsd", h, w_down)

    x = A_q
    xn = _layernorm(x, axis=-1)
    return x + _A_ref(xn, A_k, A_v, A_shift_k, A_ssm_k, A_ssm_D) + _B_ref(xn, B_w_gate, B_w_up, B_w_down)
```

```asm
; @launch grid=(256,1,1) block=(256,1,1) lds=161536
.amdgcn_target "amdgcn-amd-amdhsa--gfx950"
.text
.globl parallel_sum__ssm_conv_h3__glu_gated_geglu__prompt_kernel
.p2align 8
.type parallel_sum__ssm_conv_h3__glu_gated_geglu__prompt_kernel,@function
parallel_sum__ssm_conv_h3__glu_gated_geglu__prompt_kernel:
s_cmp_ge_u32 s2, 256
s_cbranch_scc1 L_done
s_load_dwordx4 s[80:83], s[0:1], 0
s_load_dwordx4 s[88:91], s[0:1], 16
s_load_dwordx4 s[68:71], s[0:1], 32
s_load_dwordx4 s[4:7], s[0:1], 56
s_load_dwordx4 s[16:19], s[0:1], 72
s_load_dwordx4 s[44:47], s[0:1], 88
v_lshrrev_b32 v2, 6, v0
v_and_b32 v1, 63, v0
v_readfirstlane_b32 s20, v2
s_and_b32 s21, s2, 7
s_lshr_b32 s22, s2, 3
s_lshl_b32 s27, s22, 2
v_lshlrev_b32 v19, 4, v1
s_getpc_b64 s[52:53]
L_pc:
s_sub_u32 s52, s52, L_pc-parallel_sum__ssm_conv_h3__glu_gated_geglu__prompt_kernel
s_subb_u32 s53, s53, 0
s_lshr_b32 s54, s2, 3
s_and_b32 s54, s54, 3
s_cmp_lg_u32 s54, s20
s_cbranch_scc1 L_nocpf
s_lshl_b32 s54, s20, 13
v_lshlrev_b32 v2, 7, v1
v_add_u32 v2, s54, v2
v_min_u32 v2, L_done-parallel_sum__ssm_conv_h3__glu_gated_geglu__prompt_kernel, v2
global_load_dword v255, v2, s[52:53]
L_nocpf:
s_add_u32 s27, s27, s20
s_and_b32 s28, s21, 0
v_and_b32 v2, 7, v1
v_mul_u32_u24 v2, 1152, v2
v_lshrrev_b32 v3, 3, v1
v_lshl_add_u32 v248, v3, 4, v2
s_xor_b32 s29, s28, 0
s_lshl_b32 s34, s22, 6
s_lshl_b32 s35, s20, 4
s_add_u32 s34, s34, s35
s_lshl_b32 s35, s29, 3
s_add_u32 s34, s34, s35
s_mul_i32 s34, s34, 1152
s_mov_b32 s99, s34
s_waitcnt lgkmcnt(0)
s_mov_b32 s84, s82
s_mov_b32 s85, s83
s_mov_b32 s82, 2359296
s_mov_b32 s83, 0x00020000
s_mov_b32 s34, s99
buffer_load_dwordx4 v[176:179], v248, s[80:83], s34 offen
buffer_load_dwordx4 v[180:183], v248, s[80:83], s34 offen offset:128
buffer_load_dwordx4 v[184:187], v248, s[80:83], s34 offen offset:256
buffer_load_dwordx4 v[188:191], v248, s[80:83], s34 offen offset:384
buffer_load_dwordx4 v[192:195], v248, s[80:83], s34 offen offset:512
buffer_load_dwordx4 v[196:199], v248, s[80:83], s34 offen offset:640
buffer_load_dwordx4 v[200:203], v248, s[80:83], s34 offen offset:768
buffer_load_dwordx4 v[204:207], v248, s[80:83], s34 offen offset:896
buffer_load_dwordx4 v[208:211], v248, s[80:83], s34 offen offset:1024
s_mov_b32 s92, s90
s_mov_b32 s93, s91
s_mov_b32 s96, s70
s_mov_b32 s97, s71
s_mov_b32 s8, s6
s_mov_b32 s9, s7
s_mov_b32 s64, s18
s_mov_b32 s65, s19
s_mov_b32 s12, s46
s_mov_b32 s13, s47
s_mov_b32 s72, s80
s_mov_b32 s73, s81
s_mov_b32 s18, 5308416
s_mov_b32 s19, 0x00020000
s_mov_b32 s6, 5308416
s_mov_b32 s7, 0x00020000
s_mov_b32 s10, 5308416
s_mov_b32 s11, 0x00020000
s_mov_b32 s14, 268435456
s_mov_b32 s15, 0x00020000
s_mov_b32 s46, 256
s_mov_b32 s47, 0x00020000
s_mov_b32 s86, 2359296
s_mov_b32 s87, 0x00020000
s_mov_b32 s90, 2359296
s_mov_b32 s91, 0x00020000
s_mov_b32 s94, 4608
s_mov_b32 s95, 0x00020000
s_mov_b32 s98, 1152
s_mov_b32 s99, 0x00020000
s_mov_b32 s66, 2359296
s_mov_b32 s67, 0x00020000
s_mov_b32 s74, 2359296
s_mov_b32 s75, 0x00020000
s_mul_i32 s34, s27, 5
v_min_u32 v2, 4, v1
v_add_u32 v2, s34, v2
v_min_u32 v2, 575, v2
v_mul_u32_u24 v11, 9216, v2
s_mul_i32 s26, s21, 1152
buffer_load_dword v252, v11, s[4:7], s26 offen
buffer_load_dword v253, v11, s[8:11], s26 offen
s_add_u32 s26, s26, 128
v_lshrrev_b32 v2, 3, v1
v_and_b32 v3, 7, v1
v_lshrrev_b32 v4, 1, v3
v_and_b32 v5, 1, v3
v_lshlrev_b32 v5, 4, v5
v_bfe_u32 v6, v1, 4, 1
v_lshlrev_b32 v7, 1, v6
s_mul_i32 s34, s20, 24
v_add_u32 v23, s34, v2
s_movk_i32 s35, 9216
v_mul_lo_u32 v21, v23, s35
s_add_u32 s35, s20, 0
s_and_b32 s35, s35, 1
s_lshl_b32 s35, s35, 1
v_or_b32 v22, s35, v6
v_xor_b32 v22, v4, v22
v_lshlrev_b32 v22, 5, v22
v_add3_u32 v22, v21, v22, v5
v_add_u32 v12, 0, v22
v_mov_b32 v15, v12
s_add_u32 s35, s20, 1
s_and_b32 s35, s35, 1
s_lshl_b32 s35, s35, 1
v_or_b32 v22, s35, v6
v_xor_b32 v22, v4, v22
v_lshlrev_b32 v22, 5, v22
v_add3_u32 v22, v21, v22, v5
v_add_u32 v13, 72704, v22
v_mov_b32 v16, v13
s_add_u32 s35, s20, 2
s_and_b32 s35, s35, 1
s_lshl_b32 s35, s35, 1
v_or_b32 v22, s35, v6
v_xor_b32 v22, v4, v22
v_lshlrev_b32 v22, 5, v22
v_add3_u32 v22, v21, v22, v5
v_add_u32 v14, 145408, v22
v_mov_b32 v17, v14
s_mul_i32 s24, s20, 3072
s_add_u32 s25, s24, 12288
s_mul_i32 s34, s20, 72
v_add_u32 v23, s34, v2
s_movk_i32 s35, 1152
v_mul_lo_u32 v21, v23, s35
v_lshrrev_b32 v22, 1, v3
v_bfe_u32 v23, v1, 4, 2
v_xor_b32 v22, v22, v23
v_lshlrev_b32 v22, 5, v22
v_and_b32 v23, 1, v3
v_lshlrev_b32 v23, 4, v23
v_add3_u32 v22, v21, v22, v23
v_add_u32 v24, 0, v22
v_add_u32 v25, 8192, v22
v_add_u32 v26, 16384, v22
v_add_u32 v27, 24576, v22
v_and_b32 v2, 15, v1
v_bfe_u32 v3, v1, 4, 1
v_lshrrev_b32 v4, 5, v1
v_lshrrev_b32 v5, 2, v2
v_bfe_u32 v6, v2, 3, 1
v_lshrrev_b32 v7, 4, v1
v_lshl_add_u32 v7, v7, 3, v5
v_lshlrev_b32 v7, 7, v7
v_lshl_add_u32 v21, v3, 1, v6
v_xor_b32 v21, s20, v21
v_lshlrev_b32 v21, 5, v21
v_and_b32 v22, 3, v2
v_lshlrev_b32 v22, 3, v22
v_add3_u32 v8, v7, v21, v22
v_add_u32 v30, 65536, v8
v_add_u32 v31, 131072, v8
v_lshrrev_b32 v7, 4, v1
v_lshl_add_u32 v7, v7, 2, v5
v_bfe_u32 v21, v7, 1, 2
v_xor_b32 v21, s20, v21
v_lshlrev_b32 v21, 5, v21
v_lshlrev_b32 v7, 7, v7
v_add3_u32 v9, v7, v21, v22
v_add_u32 v10, 32768, v9
s_mov_b32 s39, 0
s_mov_b32 s42, 0
s_lshl_b32 s34, s21, 5
s_add_u32 s34, s34, s22
s_mul_i32 s34, s34, 73728
s_mul_i32 s35, s20, 2048
s_add_u32 s34, s34, s35
s_add_u32 s38, s34, 7340032
s_mul_i32 s23, s21, 1152
s_mov_b32 s31, 884736
s_mov_b32 s32, 4290543744
s_lshl_b32 s34, s22, 7
s_lshl_b32 s35, s21, 4
s_add_u32 s35, s35, s34
s_lshl_b32 s34, s20, 2
s_add_u32 s35, s35, s34
s_add_u32 s56, s35, 7274496
s_lshl_b32 s70, s20, 8
s_add_u32 s70, s70, s2
v_lshrrev_b32 v40, 3, v1
v_lshrrev_b32 v41, 2, v40
v_lshlrev_b32 v42, 12, v41
v_and_b32 v41, 3, v40
v_lshl_add_u32 v42, v41, 8, v42
v_and_b32 v41, 7, v1
v_lshl_add_u32 v42, v41, 4, v42
s_lshl_b32 s34, s20, 10
s_add_u32 s34, s34, 73728
v_add_u32 v42, s34, v42
s_lshl_b32 s34, s20, 6
s_add_u32 s34, s34, 147456
v_lshlrev_b32 v43, 2, v41
v_add_u32 v43, s34, v43
s_lshl_b32 s34, s22, 6
s_lshl_b32 s35, s20, 4
s_add_u32 s34, s34, s35
v_add_u32 v44, s34, v41
v_lshlrev_b32 v44, 3, v44
v_add_u32 v44, 2359296, v44
s_xor_b32 s29, s28, 1
s_lshl_b32 s34, s22, 6
s_lshl_b32 s35, s20, 4
s_add_u32 s34, s34, s35
s_lshl_b32 s35, s29, 3
s_add_u32 s34, s34, s35
s_mul_i32 s34, s34, 1152
buffer_load_dwordx4 v[212:215], v248, s[80:83], s34 offen
buffer_load_dwordx4 v[216:219], v248, s[80:83], s34 offen offset:128
buffer_load_dwordx4 v[220:223], v248, s[80:83], s34 offen offset:256
buffer_load_dwordx4 v[224:227], v248, s[80:83], s34 offen offset:384
buffer_load_dwordx4 v[228:231], v248, s[80:83], s34 offen offset:512
buffer_load_dwordx4 v[232:235], v248, s[80:83], s34 offen offset:640
buffer_load_dwordx4 v[236:239], v248, s[80:83], s34 offen offset:768
buffer_load_dwordx4 v[240:243], v248, s[80:83], s34 offen offset:896
buffer_load_dwordx4 v[244:247], v248, s[80:83], s34 offen offset:1024
s_waitcnt vmcnt(11)
s_mov_b32 s36, 0x3f803f80
s_mov_b32 s37, 0x00003f80
s_mov_b32 s40, 0x3f800000
s_xor_b32 s29, s28, 0
s_lshl_b32 s34, s29, 7
v_add_u32 v45, s34, v42
s_lshl_b32 s34, s29, 5
v_add_u32 v46, s34, v43
v_mov_b32 v32, 0
v_mov_b32 v36, 0
v_mov_b32 v33, 0
v_mov_b32 v37, 0
v_mov_b32 v34, 0
v_mov_b32 v38, 0
v_mov_b32 v35, 0
v_mov_b32 v39, 0
v_dot2c_f32_bf16 v32, s36, v176
v_dot2c_f32_bf16 v36, v176, v176
v_dot2c_f32_bf16 v33, s36, v177
v_dot2c_f32_bf16 v37, v177, v177
v_dot2c_f32_bf16 v34, s36, v178
v_dot2c_f32_bf16 v38, v178, v178
v_dot2c_f32_bf16 v35, s36, v179
v_dot2c_f32_bf16 v39, v179, v179
v_dot2c_f32_bf16 v32, s36, v180
v_dot2c_f32_bf16 v36, v180, v180
v_dot2c_f32_bf16 v33, s36, v181
v_dot2c_f32_bf16 v37, v181, v181
v_dot2c_f32_bf16 v34, s36, v182
v_dot2c_f32_bf16 v38, v182, v182
v_dot2c_f32_bf16 v35, s36, v183
v_dot2c_f32_bf16 v39, v183, v183
v_dot2c_f32_bf16 v32, s36, v184
v_dot2c_f32_bf16 v36, v184, v184
v_dot2c_f32_bf16 v33, s36, v185
v_dot2c_f32_bf16 v37, v185, v185
v_dot2c_f32_bf16 v34, s36, v186
v_dot2c_f32_bf16 v38, v186, v186
v_dot2c_f32_bf16 v35, s36, v187
v_dot2c_f32_bf16 v39, v187, v187
v_dot2c_f32_bf16 v32, s36, v188
v_dot2c_f32_bf16 v36, v188, v188
v_dot2c_f32_bf16 v33, s36, v189
v_dot2c_f32_bf16 v37, v189, v189
v_dot2c_f32_bf16 v34, s36, v190
v_dot2c_f32_bf16 v38, v190, v190
v_dot2c_f32_bf16 v35, s36, v191
v_dot2c_f32_bf16 v39, v191, v191
v_dot2c_f32_bf16 v32, s36, v192
v_dot2c_f32_bf16 v36, v192, v192
v_dot2c_f32_bf16 v33, s36, v193
v_dot2c_f32_bf16 v37, v193, v193
v_dot2c_f32_bf16 v34, s36, v194
v_dot2c_f32_bf16 v38, v194, v194
v_dot2c_f32_bf16 v35, s36, v195
v_dot2c_f32_bf16 v39, v195, v195
v_dot2c_f32_bf16 v32, s36, v196
v_dot2c_f32_bf16 v36, v196, v196
v_dot2c_f32_bf16 v33, s36, v197
v_dot2c_f32_bf16 v37, v197, v197
v_dot2c_f32_bf16 v34, s36, v198
v_dot2c_f32_bf16 v38, v198, v198
v_dot2c_f32_bf16 v35, s36, v199
v_dot2c_f32_bf16 v39, v199, v199
v_dot2c_f32_bf16 v32, s36, v200
v_dot2c_f32_bf16 v36, v200, v200
v_dot2c_f32_bf16 v33, s36, v201
v_dot2c_f32_bf16 v37, v201, v201
v_dot2c_f32_bf16 v34, s36, v202
v_dot2c_f32_bf16 v38, v202, v202
v_dot2c_f32_bf16 v35, s36, v203
v_dot2c_f32_bf16 v39, v203, v203
v_dot2c_f32_bf16 v32, s36, v204
v_dot2c_f32_bf16 v36, v204, v204
v_dot2c_f32_bf16 v33, s36, v205
v_dot2c_f32_bf16 v37, v205, v205
v_dot2c_f32_bf16 v34, s36, v206
v_dot2c_f32_bf16 v38, v206, v206
v_dot2c_f32_bf16 v35, s36, v207
v_dot2c_f32_bf16 v39, v207, v207
v_dot2c_f32_bf16 v32, s36, v208
v_dot2c_f32_bf16 v36, v208, v208
v_dot2c_f32_bf16 v33, s36, v209
v_dot2c_f32_bf16 v37, v209, v209
v_dot2c_f32_bf16 v34, s36, v210
v_dot2c_f32_bf16 v38, v210, v210
v_dot2c_f32_bf16 v35, s36, v211
v_dot2c_f32_bf16 v39, v211, v211
s_nop 2
v_add_f32 v32, v32, v33
v_add_f32 v34, v34, v35
v_add_f32 v36, v36, v37
v_add_f32 v38, v38, v39
v_add_f32 v32, v32, v34
v_add_f32 v36, v36, v38
s_nop 1
v_add_f32_dpp v32, v32, v32 row_ror:8 row_mask:0xf bank_mask:0xf
v_add_f32_dpp v36, v36, v36 row_ror:8 row_mask:0xf bank_mask:0xf
v_mov_b32 v33, v32
v_mov_b32 v37, v36
s_nop 1
v_permlane16_swap_b32 v32, v33
v_permlane16_swap_b32 v36, v37
s_nop 1
v_add_f32 v32, v32, v33
v_add_f32 v36, v36, v37
v_mov_b32 v33, v32
v_mov_b32 v37, v36
s_nop 1
v_permlane32_swap_b32 v32, v33
v_permlane32_swap_b32 v36, v37
s_nop 1
v_add_f32 v32, v32, v33
v_add_f32 v36, v36, v37
v_mul_f32 v32, 0x3ae38e39, v32
v_mul_f32 v36, 0x3ae38e39, v36
v_fma_f32 v36, -v32, v32, v36
v_max_f32 v36, 0, v36
v_cvt_pk_bf16_f32 v33, v32, v36
v_and_b32 v36, 0xffff0000, v33
v_lshlrev_b32 v32, 16, v33
v_add_f32 v36, 0x3727c5ac, v36
v_cvt_pk_bf16_f32 v36, v36, v36
v_lshlrev_b32 v36, 16, v36
v_sqrt_f32 v36, v36
s_nop 0
v_cvt_pk_bf16_f32 v36, v36, v36
v_lshlrev_b32 v33, 16, v36
v_rcp_f32 v36, v33
v_sub_f32 v34, 0, v32
ds_write_b32 v46, v36
s_lshl_b32 s34, s29, 6
s_cmp_eq_u32 s21, 0
s_cselect_b32 s34, s34, 0x7ff00000
buffer_store_dwordx2 v[32:33], v44, s[12:15], s34 offen sc1
v_dot2_f32_bf16 v48, v176, s37, v34
v_dot2_f32_bf16 v49, v176, s40, v34
v_dot2_f32_bf16 v50, v177, s37, v34
v_dot2_f32_bf16 v51, v177, s40, v34
v_dot2_f32_bf16 v52, v178, s37, v34
v_dot2_f32_bf16 v53, v178, s40, v34
v_dot2_f32_bf16 v54, v179, s37, v34
v_dot2_f32_bf16 v55, v179, s40, v34
v_dot2_f32_bf16 v60, v180, s37, v34
v_dot2_f32_bf16 v61, v180, s40, v34
v_dot2_f32_bf16 v62, v181, s37, v34
v_dot2_f32_bf16 v63, v181, s40, v34
v_dot2_f32_bf16 v64, v182, s37, v34
v_dot2_f32_bf16 v65, v182, s40, v34
v_dot2_f32_bf16 v66, v183, s37, v34
v_dot2_f32_bf16 v67, v183, s40, v34
v_cvt_pk_bf16_f32 v56, v48, v49
v_cvt_pk_bf16_f32 v57, v50, v51
v_cvt_pk_bf16_f32 v58, v52, v53
v_cvt_pk_bf16_f32 v59, v54, v55
ds_write_b128 v45, v[56:59] offset:0
v_dot2_f32_bf16 v48, v184, s37, v34
v_dot2_f32_bf16 v49, v184, s40, v34
v_dot2_f32_bf16 v50, v185, s37, v34
v_dot2_f32_bf16 v51, v185, s40, v34
v_dot2_f32_bf16 v52, v186, s37, v34
v_dot2_f32_bf16 v53, v186, s40, v34
v_dot2_f32_bf16 v54, v187, s37, v34
v_dot2_f32_bf16 v55, v187, s40, v34
v_cvt_pk_bf16_f32 v68, v60, v61
v_cvt_pk_bf16_f32 v69, v62, v63
v_cvt_pk_bf16_f32 v70, v64, v65
v_cvt_pk_bf16_f32 v71, v66, v67
ds_write_b128 v45, v[68:71] offset:8192
v_dot2_f32_bf16 v60, v188, s37, v34
v_dot2_f32_bf16 v61, v188, s40, v34
v_dot2_f32_bf16 v62, v189, s37, v34
v_dot2_f32_bf16 v63, v189, s40, v34
v_dot2_f32_bf16 v64, v190, s37, v34
v_dot2_f32_bf16 v65, v190, s40, v34
v_dot2_f32_bf16 v66, v191, s37, v34
v_dot2_f32_bf16 v67, v191, s40, v34
v_cvt_pk_bf16_f32 v56, v48, v49
v_cvt_pk_bf16_f32 v57, v50, v51
v_cvt_pk_bf16_f32 v58, v52, v53
v_cvt_pk_bf16_f32 v59, v54, v55
ds_write_b128 v45, v[56:59] offset:16384
v_dot2_f32_bf16 v48, v192, s37, v34
v_dot2_f32_bf16 v49, v192, s40, v34
v_dot2_f32_bf16 v50, v193, s37, v34
v_dot2_f32_bf16 v51, v193, s40, v34
v_dot2_f32_bf16 v52, v194, s37, v34
v_dot2_f32_bf16 v53, v194, s40, v34
v_dot2_f32_bf16 v54, v195, s37, v34
v_dot2_f32_bf16 v55, v195, s40, v34
v_cvt_pk_bf16_f32 v68, v60, v61
v_cvt_pk_bf16_f32 v69, v62, v63
v_cvt_pk_bf16_f32 v70, v64, v65
v_cvt_pk_bf16_f32 v71, v66, v67
ds_write_b128 v45, v[68:71] offset:24576
v_dot2_f32_bf16 v60, v196, s37, v34
v_dot2_f32_bf16 v61, v196, s40, v34
v_dot2_f32_bf16 v62, v197, s37, v34
v_dot2_f32_bf16 v63, v197, s40, v34
v_dot2_f32_bf16 v64, v198, s37, v34
v_dot2_f32_bf16 v65, v198, s40, v34
v_dot2_f32_bf16 v66, v199, s37, v34
v_dot2_f32_bf16 v67, v199, s40, v34
v_cvt_pk_bf16_f32 v56, v48, v49
v_cvt_pk_bf16_f32 v57, v50, v51
v_cvt_pk_bf16_f32 v58, v52, v53
v_cvt_pk_bf16_f32 v59, v54, v55
ds_write_b128 v45, v[56:59] offset:32768
v_dot2_f32_bf16 v48, v200, s37, v34
v_dot2_f32_bf16 v49, v200, s40, v34
v_dot2_f32_bf16 v50, v201, s37, v34
v_dot2_f32_bf16 v51, v201, s40, v34
v_dot2_f32_bf16 v52, v202, s37, v34
v_dot2_f32_bf16 v53, v202, s40, v34
v_dot2_f32_bf16 v54, v203, s37, v34
v_dot2_f32_bf16 v55, v203, s40, v34
v_cvt_pk_bf16_f32 v68, v60, v61
v_cvt_pk_bf16_f32 v69, v62, v63
v_cvt_pk_bf16_f32 v70, v64, v65
v_cvt_pk_bf16_f32 v71, v66, v67
ds_write_b128 v45, v[68:71] offset:40960
v_dot2_f32_bf16 v60, v204, s37, v34
v_dot2_f32_bf16 v61, v204, s40, v34
v_dot2_f32_bf16 v62, v205, s37, v34
v_dot2_f32_bf16 v63, v205, s40, v34
v_dot2_f32_bf16 v64, v206, s37, v34
v_dot2_f32_bf16 v65, v206, s40, v34
v_dot2_f32_bf16 v66, v207, s37, v34
v_dot2_f32_bf16 v67, v207, s40, v34
v_cvt_pk_bf16_f32 v56, v48, v49
v_cvt_pk_bf16_f32 v57, v50, v51
v_cvt_pk_bf16_f32 v58, v52, v53
v_cvt_pk_bf16_f32 v59, v54, v55
ds_write_b128 v45, v[56:59] offset:49152
v_dot2_f32_bf16 v48, v208, s37, v34
v_dot2_f32_bf16 v49, v208, s40, v34
v_dot2_f32_bf16 v50, v209, s37, v34
v_dot2_f32_bf16 v51, v209, s40, v34
v_dot2_f32_bf16 v52, v210, s37, v34
v_dot2_f32_bf16 v53, v210, s40, v34
v_dot2_f32_bf16 v54, v211, s37, v34
v_dot2_f32_bf16 v55, v211, s40, v34
v_cvt_pk_bf16_f32 v68, v60, v61
v_cvt_pk_bf16_f32 v69, v62, v63
v_cvt_pk_bf16_f32 v70, v64, v65
v_cvt_pk_bf16_f32 v71, v66, v67
ds_write_b128 v45, v[68:71] offset:57344
s_nop 2
v_cvt_pk_bf16_f32 v56, v48, v49
v_cvt_pk_bf16_f32 v57, v50, v51
v_cvt_pk_bf16_f32 v58, v52, v53
v_cvt_pk_bf16_f32 v59, v54, v55
v_add_u32 v45, 32768, v45
ds_write_b128 v45, v[56:59] offset:32768
s_waitcnt vmcnt(1)
buffer_load_dword v252, v11, s[4:7], s26 offen
buffer_load_dword v253, v11, s[8:11], s26 offen
s_add_u32 s26, s26, 128
buffer_load_dword v252, v11, s[4:7], s26 offen
buffer_load_dword v253, v11, s[8:11], s26 offen
s_add_u32 s26, s26, 128
s_mul_i32 s52, s20, 36
v_min_u32 v2, 35, v1
v_add_u32 v2, s52, v2
s_mov_b32 s53, 477218589
v_mul_hi_u32 v251, v2, s53
v_mul_u32_u24 v250, 9, v251
v_sub_u32 v250, v2, v250
s_lshl_b32 s52, s22, 6
v_lshlrev_b32 v3, 2, v251
v_add_u32 v3, s52, v3
v_mul_u32_u24 v3, 1152, v3
s_mul_i32 s52, s21, 144
v_lshl_add_u32 v4, v250, 4, v3
v_add_u32 v4, s52, v4
v_add_u32 v3, 4294963840, v4
buffer_load_dwordx4 v[176:179], v3, s[84:87], 0 offen nt
v_add_u32 v3, 4294964992, v4
buffer_load_dwordx4 v[180:183], v3, s[84:87], 0 offen nt
v_add_u32 v3, 4294966144, v4
buffer_load_dwordx4 v[184:187], v3, s[84:87], 0 offen nt
buffer_load_dwordx4 v[188:191], v4, s[84:87], 0 offen nt
buffer_load_dwordx4 v[192:195], v4, s[84:87], 0 offen offset:1152 nt
buffer_load_dwordx4 v[196:199], v4, s[84:87], 0 offen offset:2304 nt
buffer_load_dwordx4 v[200:203], v4, s[84:87], 0 offen offset:3456 nt
buffer_load_dwordx4 v[112:115], v4, s[88:91], 0 offen nt
buffer_load_dwordx4 v[116:119], v4, s[88:91], 0 offen offset:1152 nt
buffer_load_dwordx4 v[120:123], v4, s[88:91], 0 offen offset:2304 nt
buffer_load_dwordx4 v[124:127], v4, s[88:91], 0 offen offset:3456 nt
s_mul_i32 s52, s21, 576
v_lshlrev_b32 v3, 6, v250
buffer_load_dwordx4 v[72:75], v3, s[92:95], s52 offen
buffer_load_dwordx4 v[76:79], v3, s[92:95], s52 offen offset:16
buffer_load_dwordx4 v[80:83], v3, s[92:95], s52 offen offset:32
buffer_load_dwordx4 v[84:87], v3, s[92:95], s52 offen offset:48
s_mov_b32 s36, 0x3f803f80
s_mov_b32 s37, 0x00003f80
s_mov_b32 s40, 0x3f800000
s_xor_b32 s29, s28, 1
s_lshl_b32 s34, s29, 7
v_add_u32 v45, s34, v42
s_lshl_b32 s34, s29, 5
v_add_u32 v46, s34, v43
v_mov_b32 v32, 0
v_mov_b32 v36, 0
v_mov_b32 v33, 0
v_mov_b32 v37, 0
v_mov_b32 v34, 0
v_mov_b32 v38, 0
v_mov_b32 v35, 0
v_mov_b32 v39, 0
v_dot2c_f32_bf16 v32, s36, v212
v_dot2c_f32_bf16 v36, v212, v212
v_dot2c_f32_bf16 v33, s36, v213
v_dot2c_f32_bf16 v37, v213, v213
v_dot2c_f32_bf16 v34, s36, v214
v_dot2c_f32_bf16 v38, v214, v214
v_dot2c_f32_bf16 v35, s36, v215
v_dot2c_f32_bf16 v39, v215, v215
v_dot2c_f32_bf16 v32, s36, v216
v_dot2c_f32_bf16 v36, v216, v216
v_dot2c_f32_bf16 v33, s36, v217
v_dot2c_f32_bf16 v37, v217, v217
v_dot2c_f32_bf16 v34, s36, v218
v_dot2c_f32_bf16 v38, v218, v218
v_dot2c_f32_bf16 v35, s36, v219
v_dot2c_f32_bf16 v39, v219, v219
v_dot2c_f32_bf16 v32, s36, v220
v_dot2c_f32_bf16 v36, v220, v220
v_dot2c_f32_bf16 v33, s36, v221
v_dot2c_f32_bf16 v37, v221, v221
v_dot2c_f32_bf16 v34, s36, v222
v_dot2c_f32_bf16 v38, v222, v222
v_dot2c_f32_bf16 v35, s36, v223
v_dot2c_f32_bf16 v39, v223, v223
v_dot2c_f32_bf16 v32, s36, v224
v_dot2c_f32_bf16 v36, v224, v224
v_dot2c_f32_bf16 v33, s36, v225
v_dot2c_f32_bf16 v37, v225, v225
v_dot2c_f32_bf16 v34, s36, v226
v_dot2c_f32_bf16 v38, v226, v226
v_dot2c_f32_bf16 v35, s36, v227
v_dot2c_f32_bf16 v39, v227, v227
v_dot2c_f32_bf16 v32, s36, v228
v_dot2c_f32_bf16 v36, v228, v228
v_dot2c_f32_bf16 v33, s36, v229
v_dot2c_f32_bf16 v37, v229, v229
v_dot2c_f32_bf16 v34, s36, v230
v_dot2c_f32_bf16 v38, v230, v230
v_dot2c_f32_bf16 v35, s36, v231
v_dot2c_f32_bf16 v39, v231, v231
v_dot2c_f32_bf16 v32, s36, v232
v_dot2c_f32_bf16 v36, v232, v232
v_dot2c_f32_bf16 v33, s36, v233
v_dot2c_f32_bf16 v37, v233, v233
v_dot2c_f32_bf16 v34, s36, v234
v_dot2c_f32_bf16 v38, v234, v234
v_dot2c_f32_bf16 v35, s36, v235
v_dot2c_f32_bf16 v39, v235, v235
v_dot2c_f32_bf16 v32, s36, v236
v_dot2c_f32_bf16 v36, v236, v236
v_dot2c_f32_bf16 v33, s36, v237
v_dot2c_f32_bf16 v37, v237, v237
v_dot2c_f32_bf16 v34, s36, v238
v_dot2c_f32_bf16 v38, v238, v238
v_dot2c_f32_bf16 v35, s36, v239
v_dot2c_f32_bf16 v39, v239, v239
v_dot2c_f32_bf16 v32, s36, v240
v_dot2c_f32_bf16 v36, v240, v240
v_dot2c_f32_bf16 v33, s36, v241
v_dot2c_f32_bf16 v37, v241, v241
v_dot2c_f32_bf16 v34, s36, v242
v_dot2c_f32_bf16 v38, v242, v242
v_dot2c_f32_bf16 v35, s36, v243
v_dot2c_f32_bf16 v39, v243, v243
v_dot2c_f32_bf16 v32, s36, v244
v_dot2c_f32_bf16 v36, v244, v244
v_dot2c_f32_bf16 v33, s36, v245
v_dot2c_f32_bf16 v37, v245, v245
v_dot2c_f32_bf16 v34, s36, v246
v_dot2c_f32_bf16 v38, v246, v246
v_dot2c_f32_bf16 v35, s36, v247
v_dot2c_f32_bf16 v39, v247, v247
s_nop 2
v_add_f32 v32, v32, v33
v_add_f32 v34, v34, v35
v_add_f32 v36, v36, v37
v_add_f32 v38, v38, v39
v_add_f32 v32, v32, v34
v_add_f32 v36, v36, v38
s_nop 1
v_add_f32_dpp v32, v32, v32 row_ror:8 row_mask:0xf bank_mask:0xf
v_add_f32_dpp v36, v36, v36 row_ror:8 row_mask:0xf bank_mask:0xf
v_mov_b32 v33, v32
v_mov_b32 v37, v36
s_nop 1
v_permlane16_swap_b32 v32, v33
v_permlane16_swap_b32 v36, v37
s_nop 1
v_add_f32 v32, v32, v33
v_add_f32 v36, v36, v37
v_mov_b32 v33, v32
v_mov_b32 v37, v36
s_nop 1
v_permlane32_swap_b32 v32, v33
v_permlane32_swap_b32 v36, v37
s_nop 1
v_add_f32 v32, v32, v33
v_add_f32 v36, v36, v37
v_mul_f32 v32, 0x3ae38e39, v32
v_mul_f32 v36, 0x3ae38e39, v36
v_fma_f32 v36, -v32, v32, v36
v_max_f32 v36, 0, v36
v_cvt_pk_bf16_f32 v33, v32, v36
v_and_b32 v36, 0xffff0000, v33
v_lshlrev_b32 v32, 16, v33
v_add_f32 v36, 0x3727c5ac, v36
v_cvt_pk_bf16_f32 v36, v36, v36
v_lshlrev_b32 v36, 16, v36
v_sqrt_f32 v36, v36
s_nop 0
v_cvt_pk_bf16_f32 v36, v36, v36
v_lshlrev_b32 v33, 16, v36
v_rcp_f32 v36, v33
v_sub_f32 v34, 0, v32
ds_write_b32 v46, v36
s_lshl_b32 s34, s29, 6
s_cmp_eq_u32 s21, 0
s_cselect_b32 s34, s34, 0x7ff00000
buffer_store_dwordx2 v[32:33], v44, s[12:15], s34 offen sc1
v_dot2_f32_bf16 v48, v212, s37, v34
v_dot2_f32_bf16 v49, v212, s40, v34
v_dot2_f32_bf16 v50, v213, s37, v34
v_dot2_f32_bf16 v51, v213, s40, v34
v_dot2_f32_bf16 v52, v214, s37, v34
v_dot2_f32_bf16 v53, v214, s40, v34
v_dot2_f32_bf16 v54, v215, s37, v34
v_dot2_f32_bf16 v55, v215, s40, v34
v_dot2_f32_bf16 v60, v216, s37, v34
v_dot2_f32_bf16 v61, v216, s40, v34
v_dot2_f32_bf16 v62, v217, s37, v34
v_dot2_f32_bf16 v63, v217, s40, v34
v_dot2_f32_bf16 v64, v218, s37, v34
v_dot2_f32_bf16 v65, v218, s40, v34
v_dot2_f32_bf16 v66, v219, s37, v34
v_dot2_f32_bf16 v67, v219, s40, v34
v_cvt_pk_bf16_f32 v56, v48, v49
v_cvt_pk_bf16_f32 v57, v50, v51
v_cvt_pk_bf16_f32 v58, v52, v53
v_cvt_pk_bf16_f32 v59, v54, v55
ds_write_b128 v45, v[56:59] offset:0
v_dot2_f32_bf16 v48, v220, s37, v34
v_dot2_f32_bf16 v49, v220, s40, v34
v_dot2_f32_bf16 v50, v221, s37, v34
v_dot2_f32_bf16 v51, v221, s40, v34
v_dot2_f32_bf16 v52, v222, s37, v34
v_dot2_f32_bf16 v53, v222, s40, v34
v_dot2_f32_bf16 v54, v223, s37, v34
v_dot2_f32_bf16 v55, v223, s40, v34
v_cvt_pk_bf16_f32 v68, v60, v61
v_cvt_pk_bf16_f32 v69, v62, v63
v_cvt_pk_bf16_f32 v70, v64, v65
v_cvt_pk_bf16_f32 v71, v66, v67
ds_write_b128 v45, v[68:71] offset:8192
v_dot2_f32_bf16 v60, v224, s37, v34
v_dot2_f32_bf16 v61, v224, s40, v34
v_dot2_f32_bf16 v62, v225, s37, v34
v_dot2_f32_bf16 v63, v225, s40, v34
v_dot2_f32_bf16 v64, v226, s37, v34
v_dot2_f32_bf16 v65, v226, s40, v34
v_dot2_f32_bf16 v66, v227, s37, v34
v_dot2_f32_bf16 v67, v227, s40, v34
v_cvt_pk_bf16_f32 v56, v48, v49
v_cvt_pk_bf16_f32 v57, v50, v51
v_cvt_pk_bf16_f32 v58, v52, v53
v_cvt_pk_bf16_f32 v59, v54, v55
ds_write_b128 v45, v[56:59] offset:16384
v_dot2_f32_bf16 v48, v228, s37, v34
v_dot2_f32_bf16 v49, v228, s40, v34
v_dot2_f32_bf16 v50, v229, s37, v34
v_dot2_f32_bf16 v51, v229, s40, v34
v_dot2_f32_bf16 v52, v230, s37, v34
v_dot2_f32_bf16 v53, v230, s40, v34
v_dot2_f32_bf16 v54, v231, s37, v34
v_dot2_f32_bf16 v55, v231, s40, v34
v_cvt_pk_bf16_f32 v68, v60, v61
v_cvt_pk_bf16_f32 v69, v62, v63
v_cvt_pk_bf16_f32 v70, v64, v65
v_cvt_pk_bf16_f32 v71, v66, v67
ds_write_b128 v45, v[68:71] offset:24576
v_dot2_f32_bf16 v60, v232, s37, v34
v_dot2_f32_bf16 v61, v232, s40, v34
v_dot2_f32_bf16 v62, v233, s37, v34
v_dot2_f32_bf16 v63, v233, s40, v34
v_dot2_f32_bf16 v64, v234, s37, v34
v_dot2_f32_bf16 v65, v234, s40, v34
v_dot2_f32_bf16 v66, v235, s37, v34
v_dot2_f32_bf16 v67, v235, s40, v34
v_cvt_pk_bf16_f32 v56, v48, v49
v_cvt_pk_bf16_f32 v57, v50, v51
v_cvt_pk_bf16_f32 v58, v52, v53
v_cvt_pk_bf16_f32 v59, v54, v55
ds_write_b128 v45, v[56:59] offset:32768
v_dot2_f32_bf16 v48, v236, s37, v34
v_dot2_f32_bf16 v49, v236, s40, v34
v_dot2_f32_bf16 v50, v237, s37, v34
v_dot2_f32_bf16 v51, v237, s40, v34
v_dot2_f32_bf16 v52, v238, s37, v34
v_dot2_f32_bf16 v53, v238, s40, v34
v_dot2_f32_bf16 v54, v239, s37, v34
v_dot2_f32_bf16 v55, v239, s40, v34
v_cvt_pk_bf16_f32 v68, v60, v61
v_cvt_pk_bf16_f32 v69, v62, v63
v_cvt_pk_bf16_f32 v70, v64, v65
v_cvt_pk_bf16_f32 v71, v66, v67
ds_write_b128 v45, v[68:71] offset:40960
v_dot2_f32_bf16 v60, v240, s37, v34
v_dot2_f32_bf16 v61, v240, s40, v34
v_dot2_f32_bf16 v62, v241, s37, v34
v_dot2_f32_bf16 v63, v241, s40, v34
v_dot2_f32_bf16 v64, v242, s37, v34
v_dot2_f32_bf16 v65, v242, s40, v34
v_dot2_f32_bf16 v66, v243, s37, v34
v_dot2_f32_bf16 v67, v243, s40, v34
v_cvt_pk_bf16_f32 v56, v48, v49
v_cvt_pk_bf16_f32 v57, v50, v51
v_cvt_pk_bf16_f32 v58, v52, v53
v_cvt_pk_bf16_f32 v59, v54, v55
ds_write_b128 v45, v[56:59] offset:49152
v_dot2_f32_bf16 v48, v244, s37, v34
v_dot2_f32_bf16 v49, v244, s40, v34
v_dot2_f32_bf16 v50, v245, s37, v34
v_dot2_f32_bf16 v51, v245, s40, v34
v_dot2_f32_bf16 v52, v246, s37, v34
v_dot2_f32_bf16 v53, v246, s40, v34
v_dot2_f32_bf16 v54, v247, s37, v34
v_dot2_f32_bf16 v55, v247, s40, v34
v_cvt_pk_bf16_f32 v68, v60, v61
v_cvt_pk_bf16_f32 v69, v62, v63
v_cvt_pk_bf16_f32 v70, v64, v65
v_cvt_pk_bf16_f32 v71, v66, v67
ds_write_b128 v45, v[68:71] offset:57344
s_nop 2
v_cvt_pk_bf16_f32 v56, v48, v49
v_cvt_pk_bf16_f32 v57, v50, v51
v_cvt_pk_bf16_f32 v58, v52, v53
v_cvt_pk_bf16_f32 v59, v54, v55
v_add_u32 v45, 32768, v45
ds_write_b128 v45, v[56:59] offset:32768
s_waitcnt lgkmcnt(0)
s_barrier
v_add_u32 v20, 73728, v19
v_add_u32 v2, 65536, v20
ds_read_b128 a[0:3], v20 offset:0
ds_read_b128 a[4:7], v20 offset:1024
s_add_u32 m0, s24, 0
s_nop 0
buffer_load_dwordx4 v12, s[4:7], s23 offen lds
ds_read_b128 a[8:11], v20 offset:2048
ds_read_b128 a[12:15], v20 offset:3072
ds_read_b128 a[16:19], v20 offset:4096
buffer_load_dwordx4 v13, s[4:7], s23 offen offset:1024 lds
ds_read_b128 a[20:23], v20 offset:5120
ds_read_b128 a[24:27], v20 offset:6144
ds_read_b128 a[28:31], v20 offset:7168
ds_read_b128 a[32:35], v20 offset:8192
buffer_load_dwordx4 v14, s[4:7], s23 offen offset:2048 lds
ds_read_b128 a[36:39], v20 offset:9216
ds_read_b128 a[40:43], v20 offset:10240
ds_read_b128 a[44:47], v20 offset:11264
ds_read_b128 a[48:51], v20 offset:12288
s_add_u32 m0, s25, 0
s_nop 0
buffer_load_dwordx4 v15, s[8:11], s23 offen lds
ds_read_b128 a[52:55], v20 offset:13312
ds_read_b128 a[56:59], v20 offset:14336
ds_read_b128 a[60:63], v20 offset:15360
buffer_load_dwordx4 v16, s[8:11], s23 offen offset:1024 lds
ds_read_b128 a[64:67], v20 offset:16384
ds_read_b128 a[68:71], v20 offset:17408
ds_read_b128 a[72:75], v20 offset:18432
ds_read_b128 a[76:79], v20 offset:19456
buffer_load_dwordx4 v17, s[8:11], s23 offen offset:2048 lds
ds_read_b128 a[80:83], v20 offset:20480
ds_read_b128 a[84:87], v20 offset:21504
ds_read_b128 a[88:91], v20 offset:22528
ds_read_b128 a[92:95], v20 offset:23552
s_add_u32 s23, s23, s31
s_add_u32 m0, s24, 24576
s_nop 0
buffer_load_dwordx4 v12, s[4:7], s23 offen lds
ds_read_b128 a[96:99], v20 offset:24576
ds_read_b128 a[100:103], v20 offset:25600
ds_read_b128 a[104:107], v20 offset:26624
buffer_load_dwordx4 v13, s[4:7], s23 offen offset:1024 lds
ds_read_b128 a[108:111], v20 offset:27648
ds_read_b128 a[112:115], v20 offset:28672
ds_read_b128 a[116:119], v20 offset:29696
ds_read_b128 a[120:123], v20 offset:30720
buffer_load_dwordx4 v14, s[4:7], s23 offen offset:2048 lds
ds_read_b128 a[124:127], v20 offset:31744
ds_read_b128 a[128:131], v20 offset:32768
ds_read_b128 a[132:135], v20 offset:33792
ds_read_b128 a[136:139], v20 offset:34816
s_add_u32 m0, s25, 24576
s_nop 0
buffer_load_dwordx4 v15, s[8:11], s23 offen lds
ds_read_b128 a[140:143], v20 offset:35840
ds_read_b128 a[144:147], v20 offset:36864
ds_read_b128 a[148:151], v20 offset:37888
buffer_load_dwordx4 v16, s[8:11], s23 offen offset:1024 lds
ds_read_b128 a[152:155], v20 offset:38912
ds_read_b128 a[156:159], v20 offset:39936
ds_read_b128 a[160:163], v20 offset:40960
ds_read_b128 a[164:167], v20 offset:41984
buffer_load_dwordx4 v17, s[8:11], s23 offen offset:2048 lds
ds_read_b128 a[168:171], v20 offset:43008
ds_read_b128 a[172:175], v20 offset:44032
ds_read_b128 a[176:179], v20 offset:45056
ds_read_b128 a[180:183], v20 offset:46080
s_add_u32 s23, s23, s31
s_add_u32 m0, s24, 49152
s_nop 0
buffer_load_dwordx4 v12, s[4:7], s23 offen lds
ds_read_b128 a[184:187], v20 offset:47104
ds_read_b128 a[188:191], v20 offset:48128
ds_read_b128 a[192:195], v20 offset:49152
buffer_load_dwordx4 v13, s[4:7], s23 offen offset:1024 lds
ds_read_b128 a[196:199], v20 offset:50176
ds_read_b128 a[200:203], v20 offset:51200
ds_read_b128 a[204:207], v20 offset:52224
ds_read_b128 a[208:211], v20 offset:53248
buffer_load_dwordx4 v14, s[4:7], s23 offen offset:2048 lds
ds_read_b128 a[212:215], v20 offset:54272
ds_read_b128 a[216:219], v20 offset:55296
ds_read_b128 a[220:223], v20 offset:56320
ds_read_b128 a[224:227], v20 offset:57344
s_add_u32 m0, s25, 49152
s_nop 0
buffer_load_dwordx4 v15, s[8:11], s23 offen lds
ds_read_b128 a[228:231], v20 offset:58368
ds_read_b128 a[232:235], v20 offset:59392
ds_read_b128 a[236:239], v20 offset:60416
buffer_load_dwordx4 v16, s[8:11], s23 offen offset:1024 lds
ds_read_b128 a[240:243], v20 offset:61440
ds_read_b128 a[244:247], v20 offset:62464
ds_read_b128 a[248:251], v20 offset:63488
ds_read_b128 a[252:255], v20 offset:64512
buffer_load_dwordx4 v17, s[8:11], s23 offen offset:2048 lds
ds_read_b128 v[128:131], v2 offset:0
ds_read_b128 v[132:135], v2 offset:1024
ds_read_b128 v[136:139], v2 offset:2048
ds_read_b128 v[140:143], v2 offset:3072
ds_read_b128 v[144:147], v2 offset:4096
ds_read_b128 v[148:151], v2 offset:5120
ds_read_b128 v[152:155], v2 offset:6144
ds_read_b128 v[156:159], v2 offset:7168
s_waitcnt lgkmcnt(0)
s_barrier
s_add_u32 s23, s23, s31
s_add_u32 m0, s24, 73728
s_nop 0
buffer_load_dwordx4 v12, s[4:7], s23 offen lds
buffer_load_dwordx4 v13, s[4:7], s23 offen offset:1024 lds
buffer_load_dwordx4 v14, s[4:7], s23 offen offset:2048 lds
s_add_u32 m0, s25, 73728
s_nop 0
buffer_load_dwordx4 v15, s[8:11], s23 offen lds
buffer_load_dwordx4 v16, s[8:11], s23 offen offset:1024 lds
buffer_load_dwordx4 v17, s[8:11], s23 offen offset:2048 lds
s_add_u32 s23, s23, s31
s_add_u32 m0, s24, 98304
s_nop 0
buffer_load_dwordx4 v12, s[4:7], s23 offen lds
buffer_load_dwordx4 v13, s[4:7], s23 offen offset:1024 lds
buffer_load_dwordx4 v14, s[4:7], s23 offen offset:2048 lds
s_lshr_b32 s34, s27, 2
s_and_b32 s63, s34, 7
s_lshr_b32 s34, s34, 3
s_lshl_b32 s34, s34, 2
s_add_u32 s34, s34, s20
s_mul_i32 s34, s34, 36
v_min_u32 v2, 35, v1
v_add_u32 v2, s34, v2
v_min_u32 v2, 575, v2
s_cmp_lt_u32 s63, 6
s_cbranch_scc0 L_pfwd
v_mul_u32_u24 v11, 9216, v2
v_mov_b32 v28, v11
s_mov_b32 s80, s4
s_mov_b32 s81, s5
s_mov_b32 s84, s8
s_mov_b32 s85, s9
s_mul_i32 s26, s21, 1152
s_add_u32 s34, s63, 3
s_lshl_b32 s34, s34, 7
s_add_u32 s26, s26, s34
s_branch L_pfok
L_pfwd:
v_mul_u32_u24 v11, 1152, v2
v_add_u32 v28, 128, v11
s_mov_b32 s80, s16
s_mov_b32 s81, s17
s_mov_b32 s84, s16
s_mov_b32 s85, s17
s_mul_i32 s26, s21, 663552
s_sub_u32 s34, s63, 6
s_lshl_b32 s34, s34, 8
s_add_u32 s26, s26, s34
L_pfok:
s_mov_b32 s82, 5308416
s_mov_b32 s83, 0x00020000
s_mov_b32 s86, 5308416
s_mov_b32 s87, 0x00020000
s_waitcnt vmcnt(15)
s_barrier
ds_read_b64_tr_b16 v[96:97], v8 offset:0
ds_read_b64_tr_b16 v[98:99], v8 offset:512
ds_read_b64_tr_b16 v[100:101], v8 offset:12288
ds_read_b64_tr_b16 v[102:103], v8 offset:12800
ds_read_b64_tr_b16 v[104:105], v8 offset:4096
ds_read_b64_tr_b16 v[106:107], v8 offset:4608
s_mov_b32 s30, 4
s_mov_b32 s62, 32
s_mov_b32 s39, 8
s_waitcnt lgkmcnt(4)
v_mfma_f32_16x16x32_bf16 v[32:35], v[96:99], a[0:3], 0
v_mfma_f32_16x16x32_bf16 v[36:39], v[96:99], a[4:7], 0
ds_read_b64_tr_b16 v[108:109], v8 offset:16384
ds_read_b64_tr_b16 v[110:111], v8 offset:16896
v_mfma_f32_16x16x32_bf16 v[40:43], v[96:99], a[8:11], 0
s_add_u32 m0, s25, 98304
s_nop 0
buffer_load_dwordx4 v15, s[8:11], s23 offen lds
v_mfma_f32_16x16x32_bf16 v[44:47], v[96:99], a[12:15], 0
s_waitcnt lgkmcnt(4)
v_mfma_f32_16x16x32_bf16 v[48:51], v[100:103], a[0:3], 0
v_mfma_f32_16x16x32_bf16 v[52:55], v[100:103], a[4:7], 0
ds_read_b64_tr_b16 v[96:97], v8 offset:8192
ds_read_b64_tr_b16 v[98:99], v8 offset:8704
v_mfma_f32_16x16x32_bf16 v[56:59], v[100:103], a[8:11], 0
buffer_load_dwordx4 v16, s[8:11], s23 offen offset:1024 lds
v_mfma_f32_16x16x32_bf16 v[60:63], v[100:103], a[12:15], 0
s_waitcnt lgkmcnt(4)
v_mfma_f32_16x16x32_bf16 v[32:35], v[104:107], a[16:19], v[32:35]
v_mfma_f32_16x16x32_bf16 v[36:39], v[104:107], a[20:23], v[36:39]
ds_read_b64_tr_b16 v[100:101], v8 offset:20480
ds_read_b64_tr_b16 v[102:103], v8 offset:20992
v_mfma_f32_16x16x32_bf16 v[40:43], v[104:107], a[24:27], v[40:43]
buffer_load_dwordx4 v17, s[8:11], s23 offen offset:2048 lds
v_mfma_f32_16x16x32_bf16 v[44:47], v[104:107], a[28:31], v[44:47]
s_waitcnt lgkmcnt(4)
v_mfma_f32_16x16x32_bf16 v[48:51], v[108:111], a[16:19], v[48:51]
v_mfma_f32_16x16x32_bf16 v[52:55], v[108:111], a[20:23], v[52:55]
ds_read_b64_tr_b16 v[104:105], v8 offset:24576
ds_read_b64_tr_b16 v[106:107], v8 offset:25088
v_mfma_f32_16x16x32_bf16 v[56:59], v[108:111], a[24:27], v[56:59]
s_add_u32 s23, s23, s31
s_add_u32 m0, s24, 122880
s_nop 0
buffer_load_dwordx4 v12, s[4:7], s23 offen lds
v_mfma_f32_16x16x32_bf16 v[60:63], v[108:111], a[28:31], v[60:63]
s_waitcnt lgkmcnt(4)
v_mfma_f32_16x16x32_bf16 v[32:35], v[96:99], a[32:35], v[32:35]
v_mfma_f32_16x16x32_bf16 v[36:39], v[96:99], a[36:39], v[36:39]
ds_read_b64_tr_b16 v[108:109], v8 offset:36864
ds_read_b64_tr_b16 v[110:111], v8 offset:37376
v_mfma_f32_16x16x32_bf16 v[40:43], v[96:99], a[40:43], v[40:43]
buffer_load_dwordx4 v13, s[4:7], s23 offen offset:1024 lds
v_mfma_f32_16x16x32_bf16 v[44:47], v[96:99], a[44:47], v[44:47]
s_waitcnt lgkmcnt(4)
v_mfma_f32_16x16x32_bf16 v[48:51], v[100:103], a[32:35], v[48:51]
s_waitcnt vmcnt(33)
s_mov_b32 s53, 0xffff0000
s_mov_b32 s52, 0x05040100
s_mov_b32 s98, 0x07060302
v_lshlrev_b32 v6, 2, v251
v_mfma_f32_16x16x32_bf16 v[52:55], v[100:103], a[36:39], v[52:55]
ds_read_b64_tr_b16 v[96:97], v8 offset:28672
ds_read_b64_tr_b16 v[98:99], v8 offset:29184
v_mfma_f32_16x16x32_bf16 v[56:59], v[100:103], a[40:43], v[56:59]
buffer_load_dwordx4 v14, s[4:7], s23 offen offset:2048 lds
v_sub_u32 v6, 63, v6
v_mul_u32_u24 v6, 160, v6
v_mfma_f32_16x16x32_bf16 v[60:63], v[100:103], a[44:47], v[60:63]
v_lshl_add_u32 v6, v250, 4, v6
v_add_u32 v6, 147232, v6
s_waitcnt lgkmcnt(4)
v_mfma_f32_16x16x32_bf16 v[32:35], v[104:107], a[48:51], v[32:35]
v_perm_b32 v208, v176, v180, s52
v_perm_b32 v209, v176, v180, s98
v_perm_b32 v210, v177, v181, s52
v_perm_b32 v211, v177, v181, s98
v_mfma_f32_16x16x32_bf16 v[36:39], v[104:107], a[52:55], v[36:39]
ds_read_b64_tr_b16 v[100:101], v8 offset:40960
ds_read_b64_tr_b16 v[102:103], v8 offset:41472
v_mfma_f32_16x16x32_bf16 v[40:43], v[104:107], a[56:59], v[40:43]
s_add_u32 m0, s25, 122880
v_perm_b32 v212, v178, v182, s52
buffer_load_dwordx4 v15, s[8:11], s23 offen lds
v_perm_b32 v213, v178, v182, s98
v_mfma_f32_16x16x32_bf16 v[44:47], v[104:107], a[60:63], v[44:47]
v_perm_b32 v214, v179, v183, s52
v_perm_b32 v215, v179, v183, s98
s_waitcnt lgkmcnt(4)
v_mfma_f32_16x16x32_bf16 v[48:51], v[108:111], a[48:51], v[48:51]
v_perm_b32 v216, v180, v184, s52
v_perm_b32 v217, v180, v184, s98
v_perm_b32 v218, v181, v185, s52
v_perm_b32 v219, v181, v185, s98
v_mfma_f32_16x16x32_bf16 v[52:55], v[108:111], a[52:55], v[52:55]
ds_read_b64_tr_b16 v[104:105], v8 offset:32768
ds_read_b64_tr_b16 v[106:107], v8 offset:33280
v_mfma_f32_16x16x32_bf16 v[56:59], v[108:111], a[56:59], v[56:59]
buffer_load_dwordx4 v16, s[8:11], s23 offen offset:1024 lds
v_perm_b32 v220, v182, v186, s52
v_perm_b32 v221, v182, v186, s98
v_mfma_f32_16x16x32_bf16 v[60:63], v[108:111], a[60:63], v[60:63]
v_perm_b32 v222, v183, v187, s52
s_waitcnt lgkmcnt(4)
v_mfma_f32_16x16x32_bf16 v[32:35], v[96:99], a[64:67], v[32:35]
v_perm_b32 v223, v183, v187, s98
v_perm_b32 v224, v184, v188, s52
v_perm_b32 v225, v184, v188, s98
v_perm_b32 v226, v185, v189, s52
v_mfma_f32_16x16x32_bf16 v[36:39], v[96:99], a[68:71], v[36:39]
ds_read_b64_tr_b16 v[108:109], v8 offset:45056
ds_read_b64_tr_b16 v[110:111], v8 offset:45568
v_mfma_f32_16x16x32_bf16 v[40:43], v[96:99], a[72:75], v[40:43]
buffer_load_dwordx4 v17, s[8:11], s23 offen offset:2048 lds
v_perm_b32 v227, v185, v189, s98
v_perm_b32 v228, v186, v190, s52
v_mfma_f32_16x16x32_bf16 v[44:47], v[96:99], a[76:79], v[44:47]
v_perm_b32 v229, v186, v190, s98
v_perm_b32 v230, v187, v191, s52
s_waitcnt lgkmcnt(4)
v_mfma_f32_16x16x32_bf16 v[48:51], v[100:103], a[64:67], v[48:51]
v_perm_b32 v231, v187, v191, s98
v_dot2_f32_bf16 v240, v208, v73, 0
v_dot2_f32_bf16 v241, v209, v75, 0
v_dot2_f32_bf16 v242, v210, v77, 0
v_mfma_f32_16x16x32_bf16 v[52:55], v[100:103], a[68:71], v[52:55]
s_waitcnt vmcnt(12) lgkmcnt(0)
s_barrier
v_mfma_f32_16x16x32_bf16 v[56:59], v[100:103], a[72:75], v[56:59]
ds_read_b64_tr_b16 v[96:97], v8 offset:49152
ds_read_b64_tr_b16 v[98:99], v8 offset:49664
s_add_u32 s23, s23, s32
s_add_u32 m0, s24, 0
v_dot2_f32_bf16 v243, v211, v79, 0
buffer_load_dwordx4 v12, s[4:7], s23 offen lds
v_dot2_f32_bf16 v244, v212, v81, 0
v_mfma_f32_16x16x32_bf16 v[60:63], v[100:103], a[76:79], v[60:63]
v_dot2_f32_bf16 v245, v213, v83, 0
v_mfma_f32_16x16x32_bf16 v[32:35], v[104:107], a[80:83], v[32:35]
v_dot2_f32_bf16 v246, v214, v85, 0
v_dot2_f32_bf16 v247, v215, v87, 0
v_dot2_f32_bf16 v240, v224, v72, v240
v_dot2_f32_bf16 v241, v225, v74, v241
v_mfma_f32_16x16x32_bf16 v[36:39], v[104:107], a[84:87], v[36:39]
ds_read_b64_tr_b16 v[100:101], v8 offset:61440
ds_read_b64_tr_b16 v[102:103], v8 offset:61952
v_mfma_f32_16x16x32_bf16 v[40:43], v[104:107], a[88:91], v[40:43]
buffer_load_dwordx4 v13, s[4:7], s23 offen offset:1024 lds
v_dot2_f32_bf16 v242, v226, v76, v242
v_dot2_f32_bf16 v243, v227, v78, v243
v_mfma_f32_16x16x32_bf16 v[44:47], v[104:107], a[92:95], v[44:47]
v_dot2_f32_bf16 v244, v228, v80, v244
v_dot2_f32_bf16 v245, v229, v82, v245
v_mfma_f32_16x16x32_bf16 v[48:51], v[108:111], a[80:83], v[48:51]
v_dot2_f32_bf16 v246, v230, v84, v246
v_dot2_f32_bf16 v247, v231, v86, v247
v_lshlrev_b32 v160, 16, v112
v_and_b32 v161, s53, v112
v_mfma_f32_16x16x32_bf16 v[52:55], v[108:111], a[84:87], v[52:55]
ds_read_b64_tr_b16 v[104:105], v8 offset:53248
ds_read_b64_tr_b16 v[106:107], v8 offset:53760
v_mfma_f32_16x16x32_bf16 v[56:59], v[108:111], a[88:91], v[56:59]
buffer_load_dwordx4 v14, s[4:7], s23 offen offset:2048 lds
v_lshlrev_b32 v162, 16, v113
v_and_b32 v163, s53, v113
v_mfma_f32_16x16x32_bf16 v[60:63], v[108:111], a[92:95], v[60:63]
v_lshlrev_b32 v164, 16, v114
s_waitcnt lgkmcnt(4)
v_mfma_f32_16x16x32_bf16 v[32:35], v[96:99], a[96:99], v[32:35]
v_and_b32 v165, s53, v114
v_lshlrev_b32 v166, 16, v115
v_and_b32 v167, s53, v115
v_mul_f32 v240, v240, v160
v_mfma_f32_16x16x32_bf16 v[36:39], v[96:99], a[100:103], v[36:39]
ds_read_b64_tr_b16 v[108:109], v30 offset:0
ds_read_b64_tr_b16 v[110:111], v30 offset:512
v_mfma_f32_16x16x32_bf16 v[40:43], v[96:99], a[104:107], v[40:43]
s_add_u32 m0, s25, 0
v_mul_f32 v241, v241, v161
buffer_load_dwordx4 v15, s[8:11], s23 offen lds
v_mul_f32 v242, v242, v162
v_mfma_f32_16x16x32_bf16 v[44:47], v[96:99], a[108:111], v[44:47]
v_mul_f32 v243, v243, v163
v_mul_f32 v244, v244, v164
s_waitcnt lgkmcnt(4)
v_mfma_f32_16x16x32_bf16 v[48:51], v[100:103], a[96:99], v[48:51]
v_mul_f32 v245, v245, v165
v_mul_f32 v246, v246, v166
v_mul_f32 v247, v247, v167
v_cvt_pk_bf16_f32 v168, v240, v241
v_mfma_f32_16x16x32_bf16 v[52:55], v[100:103], a[100:103], v[52:55]
ds_read_b64_tr_b16 v[96:97], v8 offset:57344
ds_read_b64_tr_b16 v[98:99], v8 offset:57856
v_mfma_f32_16x16x32_bf16 v[56:59], v[100:103], a[104:107], v[56:59]
buffer_load_dwordx4 v16, s[8:11], s23 offen offset:1024 lds
v_cvt_pk_bf16_f32 v169, v242, v243
v_cvt_pk_bf16_f32 v170, v244, v245
v_mfma_f32_16x16x32_bf16 v[60:63], v[100:103], a[108:111], v[60:63]
v_cvt_pk_bf16_f32 v171, v246, v247
s_waitcnt lgkmcnt(4)
v_mfma_f32_16x16x32_bf16 v[32:35], v[104:107], a[112:115], v[32:35]
ds_write_b128 v6, v[168:171] offset:480
v_perm_b32 v232, v188, v192, s52
v_perm_b32 v233, v188, v192, s98
v_perm_b32 v234, v189, v193, s52
v_mfma_f32_16x16x32_bf16 v[36:39], v[104:107], a[116:119], v[36:39]
ds_read_b64_tr_b16 v[100:101], v30 offset:4096
ds_read_b64_tr_b16 v[102:103], v30 offset:4608
v_mfma_f32_16x16x32_bf16 v[40:43], v[104:107], a[120:123], v[40:43]
buffer_load_dwordx4 v17, s[8:11], s23 offen offset:2048 lds
v_perm_b32 v235, v189, v193, s98
v_perm_b32 v236, v190, v194, s52
v_mfma_f32_16x16x32_bf16 v[44:47], v[104:107], a[124:127], v[44:47]
v_perm_b32 v237, v190, v194, s98
v_perm_b32 v238, v191, v195, s52
s_waitcnt lgkmcnt(5)
v_mfma_f32_16x16x32_bf16 v[48:51], v[108:111], a[112:115], v[48:51]
v_perm_b32 v239, v191, v195, s98
v_dot2_f32_bf16 v240, v216, v73, 0
v_dot2_f32_bf16 v241, v217, v75, 0
v_dot2_f32_bf16 v242, v218, v77, 0
v_mfma_f32_16x16x32_bf16 v[52:55], v[108:111], a[116:119], v[52:55]
ds_read_b64_tr_b16 v[104:105], v30 offset:8192
ds_read_b64_tr_b16 v[106:107], v30 offset:8704
v_mfma_f32_16x16x32_bf16 v[56:59], v[108:111], a[120:123], v[56:59]
s_add_u32 s23, s23, s31
s_add_u32 m0, s24, 24576
v_dot2_f32_bf16 v243, v219, v79, 0
buffer_load_dwordx4 v12, s[4:7], s23 offen lds
v_dot2_f32_bf16 v244, v220, v81, 0
v_mfma_f32_16x16x32_bf16 v[60:63], v[108:111], a[124:127], v[60:63]
v_dot2_f32_bf16 v245, v221, v83, 0
v_dot2_f32_bf16 v246, v222, v85, 0
s_waitcnt lgkmcnt(5)
v_mfma_f32_16x16x32_bf16 v[32:35], v[96:99], a[128:131], v[32:35]
v_dot2_f32_bf16 v247, v223, v87, 0
v_dot2_f32_bf16 v240, v232, v72, v240
v_dot2_f32_bf16 v241, v233, v74, v241
v_dot2_f32_bf16 v242, v234, v76, v242
v_mfma_f32_16x16x32_bf16 v[36:39], v[96:99], a[132:135], v[36:39]
ds_read_b64_tr_b16 v[108:109], v30 offset:20480
ds_read_b64_tr_b16 v[110:111], v30 offset:20992
v_mfma_f32_16x16x32_bf16 v[40:43], v[96:99], a[136:139], v[40:43]
buffer_load_dwordx4 v13, s[4:7], s23 offen offset:1024 lds
v_dot2_f32_bf16 v243, v235, v78, v243
v_dot2_f32_bf16 v244, v236, v80, v244
v_mfma_f32_16x16x32_bf16 v[44:47], v[96:99], a[140:143], v[44:47]
v_dot2_f32_bf16 v245, v237, v82, v245
s_waitcnt lgkmcnt(4)
v_mfma_f32_16x16x32_bf16 v[48:51], v[100:103], a[128:131], v[48:51]
v_dot2_f32_bf16 v246, v238, v84, v246
v_dot2_f32_bf16 v247, v239, v86, v247
v_lshlrev_b32 v160, 16, v116
v_and_b32 v161, s53, v116
v_mfma_f32_16x16x32_bf16 v[52:55], v[100:103], a[132:135], v[52:55]
ds_read_b64_tr_b16 v[96:97], v30 offset:12288
ds_read_b64_tr_b16 v[98:99], v30 offset:12800
v_mfma_f32_16x16x32_bf16 v[56:59], v[100:103], a[136:139], v[56:59]
buffer_load_dwordx4 v14, s[4:7], s23 offen offset:2048 lds
v_lshlrev_b32 v162, 16, v117
v_and_b32 v163, s53, v117
v_mfma_f32_16x16x32_bf16 v[60:63], v[100:103], a[140:143], v[60:63]
v_lshlrev_b32 v164, 16, v118
v_and_b32 v165, s53, v118
s_waitcnt lgkmcnt(4)
v_mfma_f32_16x16x32_bf16 v[32:35], v[104:107], a[144:147], v[32:35]
v_lshlrev_b32 v166, 16, v119
v_and_b32 v167, s53, v119
v_mul_f32 v240, v240, v160
v_mul_f32 v241, v241, v161
v_mfma_f32_16x16x32_bf16 v[36:39], v[104:107], a[148:151], v[36:39]
ds_read_b64_tr_b16 v[100:101], v30 offset:24576
ds_read_b64_tr_b16 v[102:103], v30 offset:25088
v_mfma_f32_16x16x32_bf16 v[40:43], v[104:107], a[152:155], v[40:43]
s_add_u32 m0, s25, 24576
v_mul_f32 v242, v242, v162
buffer_load_dwordx4 v15, s[8:11], s23 offen lds
v_mul_f32 v243, v243, v163
v_mfma_f32_16x16x32_bf16 v[44:47], v[104:107], a[156:159], v[44:47]
v_mul_f32 v244, v244, v164
s_waitcnt lgkmcnt(4)
v_mfma_f32_16x16x32_bf16 v[48:51], v[108:111], a[144:147], v[48:51]
v_mul_f32 v245, v245, v165
v_mul_f32 v246, v246, v166
v_mul_f32 v247, v247, v167
v_cvt_pk_bf16_f32 v168, v240, v241
v_mfma_f32_16x16x32_bf16 v[52:55], v[108:111], a[148:151], v[52:55]
ds_read_b64_tr_b16 v[104:105], v30 offset:16384
ds_read_b64_tr_b16 v[106:107], v30 offset:16896
v_mfma_f32_16x16x32_bf16 v[56:59], v[108:111], a[152:155], v[56:59]
buffer_load_dwordx4 v16, s[8:11], s23 offen offset:1024 lds
v_cvt_pk_bf16_f32 v169, v242, v243
v_cvt_pk_bf16_f32 v170, v244, v245
v_mfma_f32_16x16x32_bf16 v[60:63], v[108:111], a[156:159], v[60:63]
v_cvt_pk_bf16_f32 v171, v246, v247
ds_write_b128 v6, v[168:171] offset:320
s_waitcnt lgkmcnt(5)
v_mfma_f32_16x16x32_bf16 v[32:35], v[96:99], a[160:163], v[32:35]
v_perm_b32 v208, v192, v196, s52
v_perm_b32 v209, v192, v196, s98
v_perm_b32 v210, v193, v197, s52
v_perm_b32 v211, v193, v197, s98
v_mfma_f32_16x16x32_bf16 v[36:39], v[96:99], a[164:167], v[36:39]
ds_read_b64_tr_b16 v[108:109], v30 offset:28672
ds_read_b64_tr_b16 v[110:111], v30 offset:29184
v_mfma_f32_16x16x32_bf16 v[40:43], v[96:99], a[168:171], v[40:43]
buffer_load_dwordx4 v17, s[8:11], s23 offen offset:2048 lds
v_perm_b32 v212, v194, v198, s52
v_perm_b32 v213, v194, v198, s98
v_mfma_f32_16x16x32_bf16 v[44:47], v[96:99], a[172:175], v[44:47]
s_sub_u32 s63, s63, 1
s_cmp_lg_u32 s63, -1
s_cbranch_scc1 L_nopfZ
buffer_load_dword v252, v11, s[80:83], s26 offen
buffer_load_dword v253, v28, s[84:87], s26 offen
L_nopfZ:
v_perm_b32 v214, v195, v199, s52
s_waitcnt lgkmcnt(5)
v_mfma_f32_16x16x32_bf16 v[48:51], v[100:103], a[160:163], v[48:51]
v_perm_b32 v215, v195, v199, s98
v_dot2_f32_bf16 v240, v224, v73, 0
v_dot2_f32_bf16 v241, v225, v75, 0
v_dot2_f32_bf16 v242, v226, v77, 0
v_mfma_f32_16x16x32_bf16 v[52:55], v[100:103], a[164:167], v[52:55]
s_waitcnt vmcnt(12) lgkmcnt(0)
s_barrier
v_mfma_f32_16x16x32_bf16 v[56:59], v[100:103], a[168:171], v[56:59]
ds_read_b64_tr_b16 v[96:97], v30 offset:32768
ds_read_b64_tr_b16 v[98:99], v30 offset:33280
s_add_u32 s23, s23, s31
s_add_u32 m0, s24, 49152
v_dot2_f32_bf16 v243, v227, v79, 0
buffer_load_dwordx4 v12, s[4:7], s23 offen lds
v_dot2_f32_bf16 v244, v228, v81, 0
v_mfma_f32_16x16x32_bf16 v[60:63], v[100:103], a[172:175], v[60:63]
v_dot2_f32_bf16 v245, v229, v83, 0
v_dot2_f32_bf16 v246, v230, v85, 0
v_mfma_f32_16x16x32_bf16 v[32:35], v[104:107], a[176:179], v[32:35]
v_dot2_f32_bf16 v247, v231, v87, 0
v_dot2_f32_bf16 v240, v208, v72, v240
v_dot2_f32_bf16 v241, v209, v74, v241
v_dot2_f32_bf16 v242, v210, v76, v242
v_mfma_f32_16x16x32_bf16 v[36:39], v[104:107], a[180:183], v[36:39]
ds_read_b64_tr_b16 v[100:101], v30 offset:45056
ds_read_b64_tr_b16 v[102:103], v30 offset:45568
v_mfma_f32_16x16x32_bf16 v[40:43], v[104:107], a[184:187], v[40:43]
buffer_load_dwordx4 v13, s[4:7], s23 offen offset:1024 lds
v_dot2_f32_bf16 v243, v211, v78, v243
v_dot2_f32_bf16 v244, v212, v80, v244
v_mfma_f32_16x16x32_bf16 v[44:47], v[104:107], a[188:191], v[44:47]
v_dot2_f32_bf16 v245, v213, v82, v245
v_mfma_f32_16x16x32_bf16 v[48:51], v[108:111], a[176:179], v[48:51]
v_dot2_f32_bf16 v246, v214, v84, v246
v_dot2_f32_bf16 v247, v215, v86, v247
v_lshlrev_b32 v160, 16, v120
v_and_b32 v161, s53, v120
v_mfma_f32_16x16x32_bf16 v[52:55], v[108:111], a[180:183], v[52:55]
ds_read_b64_tr_b16 v[104:105], v30 offset:36864
ds_read_b64_tr_b16 v[106:107], v30 offset:37376
v_mfma_f32_16x16x32_bf16 v[56:59], v[108:111], a[184:187], v[56:59]
buffer_load_dwordx4 v14, s[4:7], s23 offen offset:2048 lds
v_lshlrev_b32 v162, 16, v121
v_and_b32 v163, s53, v121
v_mfma_f32_16x16x32_bf16 v[60:63], v[108:111], a[188:191], v[60:63]
v_lshlrev_b32 v164, 16, v122
v_and_b32 v165, s53, v122
s_waitcnt lgkmcnt(4)
v_mfma_f32_16x16x32_bf16 v[32:35], v[96:99], a[192:195], v[32:35]
v_lshlrev_b32 v166, 16, v123
v_and_b32 v167, s53, v123
v_mul_f32 v240, v240, v160
v_mul_f32 v241, v241, v161
v_mfma_f32_16x16x32_bf16 v[36:39], v[96:99], a[196:199], v[36:39]
ds_read_b64_tr_b16 v[108:109], v30 offset:49152
ds_read_b64_tr_b16 v[110:111], v30 offset:49664
v_mfma_f32_16x16x32_bf16 v[40:43], v[96:99], a[200:203], v[40:43]
s_add_u32 m0, s25, 49152
v_mul_f32 v242, v242, v162
buffer_load_dwordx4 v15, s[8:11], s23 offen lds
v_mul_f32 v243, v243, v163
v_mfma_f32_16x16x32_bf16 v[44:47], v[96:99], a[204:207], v[44:47]
v_mul_f32 v244, v244, v164
v_mul_f32 v245, v245, v165
s_waitcnt lgkmcnt(4)
v_mfma_f32_16x16x32_bf16 v[48:51], v[100:103], a[192:195], v[48:51]
v_mul_f32 v246, v246, v166
v_mul_f32 v247, v247, v167
v_cvt_pk_bf16_f32 v168, v240, v241
v_cvt_pk_bf16_f32 v169, v242, v243
v_mfma_f32_16x16x32_bf16 v[52:55], v[100:103], a[196:199], v[52:55]
ds_read_b64_tr_b16 v[96:97], v30 offset:40960
ds_read_b64_tr_b16 v[98:99], v30 offset:41472
v_mfma_f32_16x16x32_bf16 v[56:59], v[100:103], a[200:203], v[56:59]
buffer_load_dwordx4 v16, s[8:11], s23 offen offset:1024 lds
v_cvt_pk_bf16_f32 v170, v244, v245
v_cvt_pk_bf16_f32 v171, v246, v247
v_mfma_f32_16x16x32_bf16 v[60:63], v[100:103], a[204:207], v[60:63]
ds_write_b128 v6, v[168:171] offset:160
s_waitcnt lgkmcnt(5)
v_mfma_f32_16x16x32_bf16 v[32:35], v[104:107], a[208:211], v[32:35]
v_perm_b32 v216, v196, v200, s52
v_perm_b32 v217, v196, v200, s98
v_perm_b32 v218, v197, v201, s52
v_perm_b32 v219, v197, v201, s98
v_mfma_f32_16x16x32_bf16 v[36:39], v[104:107], a[212:215], v[36:39]
ds_read_b64_tr_b16 v[100:101], v30 offset:53248
ds_read_b64_tr_b16 v[102:103], v30 offset:53760
v_mfma_f32_16x16x32_bf16 v[40:43], v[104:107], a[216:219], v[40:43]
buffer_load_dwordx4 v17, s[8:11], s23 offen offset:2048 lds
v_perm_b32 v220, v198, v202, s52
v_perm_b32 v221, v198, v202, s98
v_mfma_f32_16x16x32_bf16 v[44:47], v[104:107], a[220:223], v[44:47]
v_perm_b32 v222, v199, v203, s52
v_perm_b32 v223, v199, v203, s98
s_waitcnt lgkmcnt(5)
v_mfma_f32_16x16x32_bf16 v[48:51], v[108:111], a[208:211], v[48:51]
v_dot2_f32_bf16 v240, v232, v73, 0
v_dot2_f32_bf16 v241, v233, v75, 0
v_dot2_f32_bf16 v242, v234, v77, 0
v_dot2_f32_bf16 v243, v235, v79, 0
v_mfma_f32_16x16x32_bf16 v[52:55], v[108:111], a[212:215], v[52:55]
ds_read_b64_tr_b16 v[104:105], v30 offset:57344
ds_read_b64_tr_b16 v[106:107], v30 offset:57856
v_mfma_f32_16x16x32_bf16 v[56:59], v[108:111], a[216:219], v[56:59]
s_add_u32 s23, s23, s31
s_add_u32 m0, s24, 73728
v_dot2_f32_bf16 v244, v236, v81, 0
buffer_load_dwordx4 v12, s[4:7], s23 offen lds
v_dot2_f32_bf16 v245, v237, v83, 0
v_mfma_f32_16x16x32_bf16 v[60:63], v[108:111], a[220:223], v[60:63]
v_dot2_f32_bf16 v246, v238, v85, 0
s_waitcnt lgkmcnt(5)
v_mfma_f32_16x16x32_bf16 v[32:35], v[96:99], a[224:227], v[32:35]
v_dot2_f32_bf16 v247, v239, v87, 0
v_dot2_f32_bf16 v240, v216, v72, v240
v_dot2_f32_bf16 v241, v217, v74, v241
v_dot2_f32_bf16 v242, v218, v76, v242
v_mfma_f32_16x16x32_bf16 v[36:39], v[96:99], a[228:231], v[36:39]
ds_read_b64_tr_b16 v[108:109], v31 offset:4096
ds_read_b64_tr_b16 v[110:111], v31 offset:4608
v_mfma_f32_16x16x32_bf16 v[40:43], v[96:99], a[232:235], v[40:43]
buffer_load_dwordx4 v13, s[4:7], s23 offen offset:1024 lds
v_dot2_f32_bf16 v243, v219, v78, v243
v_dot2_f32_bf16 v244, v220, v80, v244
v_mfma_f32_16x16x32_bf16 v[44:47], v[96:99], a[236:239], v[44:47]
v_dot2_f32_bf16 v245, v221, v82, v245
v_dot2_f32_bf16 v246, v222, v84, v246
s_waitcnt lgkmcnt(4)
v_mfma_f32_16x16x32_bf16 v[48:51], v[100:103], a[224:227], v[48:51]
v_dot2_f32_bf16 v247, v223, v86, v247
v_lshlrev_b32 v160, 16, v124
v_and_b32 v161, s53, v124
v_lshlrev_b32 v162, 16, v125
v_mfma_f32_16x16x32_bf16 v[52:55], v[100:103], a[228:231], v[52:55]
ds_read_b64_tr_b16 v[96:97], v30 offset:61440
ds_read_b64_tr_b16 v[98:99], v30 offset:61952
v_mfma_f32_16x16x32_bf16 v[56:59], v[100:103], a[232:235], v[56:59]
buffer_load_dwordx4 v14, s[4:7], s23 offen offset:2048 lds
v_and_b32 v163, s53, v125
v_lshlrev_b32 v164, 16, v126
v_mfma_f32_16x16x32_bf16 v[60:63], v[100:103], a[236:239], v[60:63]
v_and_b32 v165, s53, v126
s_waitcnt lgkmcnt(4)
v_mfma_f32_16x16x32_bf16 v[32:35], v[104:107], a[240:243], v[32:35]
v_lshlrev_b32 v166, 16, v127
v_and_b32 v167, s53, v127
v_mul_f32 v240, v240, v160
v_mul_f32 v241, v241, v161
v_mfma_f32_16x16x32_bf16 v[36:39], v[104:107], a[244:247], v[36:39]
ds_read_b64_tr_b16 v[100:101], v31 offset:8192
ds_read_b64_tr_b16 v[102:103], v31 offset:8704
v_mfma_f32_16x16x32_bf16 v[40:43], v[104:107], a[248:251], v[40:43]
s_add_u32 m0, s25, 73728
v_mul_f32 v242, v242, v162
buffer_load_dwordx4 v15, s[8:11], s23 offen lds
v_mul_f32 v243, v243, v163
v_mfma_f32_16x16x32_bf16 v[44:47], v[104:107], a[252:255], v[44:47]
v_mul_f32 v244, v244, v164
v_mul_f32 v245, v245, v165
s_waitcnt lgkmcnt(4)
v_mfma_f32_16x16x32_bf16 v[48:51], v[108:111], a[240:243], v[48:51]
v_mul_f32 v246, v246, v166
v_mul_f32 v247, v247, v167
v_cvt_pk_bf16_f32 v168, v240, v241
v_cvt_pk_bf16_f32 v169, v242, v243
v_mfma_f32_16x16x32_bf16 v[52:55], v[108:111], a[244:247], v[52:55]
ds_read_b64_tr_b16 v[104:105], v31 offset:0
ds_read_b64_tr_b16 v[106:107], v31 offset:512
v_mfma_f32_16x16x32_bf16 v[56:59], v[108:111], a[248:251], v[56:59]
buffer_load_dwordx4 v16, s[8:11], s23 offen offset:1024 lds
v_cvt_pk_bf16_f32 v170, v244, v245
v_cvt_pk_bf16_f32 v171, v246, v247
v_mfma_f32_16x16x32_bf16 v[60:63], v[108:111], a[252:255], v[60:63]
ds_write_b128 v6, v[168:171] offset:0
s_waitcnt lgkmcnt(5)
v_mfma_f32_16x16x32_bf16 v[32:35], v[96:99], v[128:131], v[32:35]
v_mfma_f32_16x16x32_bf16 v[36:39], v[96:99], v[132:135], v[36:39]
ds_read_b64_tr_b16 v[108:109], v31 offset:12288
ds_read_b64_tr_b16 v[110:111], v31 offset:12800
v_mfma_f32_16x16x32_bf16 v[40:43], v[96:99], v[136:139], v[40:43]
buffer_load_dwordx4 v17, s[8:11], s23 offen offset:2048 lds
v_mfma_f32_16x16x32_bf16 v[44:47], v[96:99], v[140:143], v[44:47]
s_waitcnt lgkmcnt(5)
v_mfma_f32_16x16x32_bf16 v[48:51], v[100:103], v[128:131], v[48:51]
v_mfma_f32_16x16x32_bf16 v[52:55], v[100:103], v[132:135], v[52:55]
s_waitcnt vmcnt(12) lgkmcnt(0)
s_barrier
v_mfma_f32_16x16x32_bf16 v[56:59], v[100:103], v[136:139], v[56:59]
ds_read_b64_tr_b16 v[96:97], v8 offset:0
ds_read_b64_tr_b16 v[98:99], v8 offset:512
s_add_u32 s23, s23, s31
s_add_u32 m0, s24, 98304
s_nop 0
buffer_load_dwordx4 v12, s[4:7], s23 offen lds
v_mfma_f32_16x16x32_bf16 v[60:63], v[100:103], v[140:143], v[60:63]
v_mfma_f32_16x16x32_bf16 v[32:35], v[104:107], v[144:147], v[32:35]
v_mfma_f32_16x16x32_bf16 v[36:39], v[104:107], v[148:151], v[36:39]
ds_read_b64_tr_b16 v[100:101], v8 offset:12288
ds_read_b64_tr_b16 v[102:103], v8 offset:12800
v_mfma_f32_16x16x32_bf16 v[40:43], v[104:107], v[152:155], v[40:43]
buffer_load_dwordx4 v13, s[4:7], s23 offen offset:1024 lds
v_mfma_f32_16x16x32_bf16 v[44:47], v[104:107], v[156:159], v[44:47]
v_mfma_f32_16x16x32_bf16 v[48:51], v[108:111], v[144:147], v[48:51]
v_mfma_f32_16x16x32_bf16 v[52:55], v[108:111], v[148:151], v[52:55]
ds_read_b64_tr_b16 v[104:105], v8 offset:4096
ds_read_b64_tr_b16 v[106:107], v8 offset:4608
v_mfma_f32_16x16x32_bf16 v[56:59], v[108:111], v[152:155], v[56:59]
buffer_load_dwordx4 v14, s[4:7], s23 offen offset:2048 lds
v_mfma_f32_16x16x32_bf16 v[60:63], v[108:111], v[156:159], v[60:63]
v_and_b32 v2, 15, v1
v_lshlrev_b32 v2, 2, v2
v_add_u32 v2, 147456, v2
ds_read_b32 v3, v2 offset:0
ds_read_b32 v4, v2 offset:64
ds_read_b32 v5, v2 offset:128
ds_read_b32 v6, v2 offset:192
s_waitcnt lgkmcnt(0)
v_mul_f32 v7, v3, v3
v_mul_f32 v18, 0xc0135761, v3
v_mul_f32 v7, v7, v3
v_mul_f32 v120, 0xbdd2d3e8, v7
v_mul_f32 v7, v4, v4
v_mul_f32 v21, 0xc0135761, v4
v_mul_f32 v7, v7, v4
v_mul_f32 v121, 0xbdd2d3e8, v7
v_mul_f32 v7, v5, v5
v_mul_f32 v22, 0xc0135761, v5
v_mul_f32 v7, v7, v5
v_mul_f32 v122, 0xbdd2d3e8, v7
v_mul_f32 v7, v6, v6
v_mul_f32 v23, 0xc0135761, v6
v_mul_f32 v7, v7, v6
v_mul_f32 v123, 0xbdd2d3e8, v7
s_mov_b32 s30, 3
L_roundA:
s_waitcnt lgkmcnt(4)
v_mfma_f32_16x16x32_bf16 v[64:67], v[96:99], a[0:3], 0
v_mfma_f32_16x16x32_bf16 v[68:71], v[96:99], a[4:7], 0
ds_read_b64_tr_b16 v[108:109], v8 offset:16384
ds_read_b64_tr_b16 v[110:111], v8 offset:16896
v_mfma_f32_16x16x32_bf16 v[72:75], v[96:99], a[8:11], 0
s_add_u32 m0, s25, 98304
s_nop 0
buffer_load_dwordx4 v15, s[8:11], s23 offen lds
v_mfma_f32_16x16x32_bf16 v[76:79], v[96:99], a[12:15], 0
s_waitcnt lgkmcnt(4)
v_mfma_f32_16x16x32_bf16 v[80:83], v[100:103], a[0:3], 0
v_mfma_f32_16x16x32_bf16 v[84:87], v[100:103], a[4:7], 0
ds_read_b64_tr_b16 v[96:97], v8 offset:8192
ds_read_b64_tr_b16 v[98:99], v8 offset:8704
v_mfma_f32_16x16x32_bf16 v[88:91], v[100:103], a[8:11], 0
buffer_load_dwordx4 v16, s[8:11], s23 offen offset:1024 lds
v_mfma_f32_16x16x32_bf16 v[92:95], v[100:103], a[12:15], 0
s_waitcnt lgkmcnt(4)
v_mfma_f32_16x16x32_bf16 v[64:67], v[104:107], a[16:19], v[64:67]
v_mul_f32 v160, v32, v32
v_mul_f32 v161, v33, v33
v_fma_f32 v160, v160, v120, v18
v_mfma_f32_16x16x32_bf16 v[68:71], v[104:107], a[20:23], v[68:71]
ds_read_b64_tr_b16 v[100:101], v8 offset:20480
ds_read_b64_tr_b16 v[102:103], v8 offset:20992
v_mfma_f32_16x16x32_bf16 v[72:75], v[104:107], a[24:27], v[72:75]
buffer_load_dwordx4 v17, s[8:11], s23 offen offset:2048 lds
v_fma_f32 v161, v161, v120, v18
v_mfma_f32_16x16x32_bf16 v[76:79], v[104:107], a[28:31], v[76:79]
v_mul_f32 v160, v160, v32
s_waitcnt lgkmcnt(4)
v_mfma_f32_16x16x32_bf16 v[80:83], v[108:111], a[16:19], v[80:83]
v_mul_f32 v161, v161, v33
v_exp_f32 v160, v160
v_mfma_f32_16x16x32_bf16 v[84:87], v[108:111], a[20:23], v[84:87]
ds_read_b64_tr_b16 v[104:105], v8 offset:24576
ds_read_b64_tr_b16 v[106:107], v8 offset:25088
v_mfma_f32_16x16x32_bf16 v[88:91], v[108:111], a[24:27], v[88:91]
s_add_u32 s23, s23, s31
s_add_u32 m0, s24, 122880
v_exp_f32 v161, v161
buffer_load_dwordx4 v12, s[4:7], s23 offen lds
v_mfma_f32_16x16x32_bf16 v[92:95], v[108:111], a[28:31], v[92:95]
v_mul_f32 v162, v32, v48
s_waitcnt lgkmcnt(4)
v_mfma_f32_16x16x32_bf16 v[64:67], v[96:99], a[32:35], v[64:67]
v_mul_f32 v163, v33, v49
v_add_f32 v160, 1.0, v160
v_add_f32 v161, 1.0, v161
v_mfma_f32_16x16x32_bf16 v[68:71], v[96:99], a[36:39], v[68:71]
ds_read_b64_tr_b16 v[108:109], v8 offset:36864
ds_read_b64_tr_b16 v[110:111], v8 offset:37376
v_mfma_f32_16x16x32_bf16 v[72:75], v[96:99], a[40:43], v[72:75]
buffer_load_dwordx4 v13, s[4:7], s23 offen offset:1024 lds
v_rcp_f32 v160, v160
v_mfma_f32_16x16x32_bf16 v[76:79], v[96:99], a[44:47], v[76:79]
v_rcp_f32 v161, v161
s_waitcnt lgkmcnt(4)
v_mfma_f32_16x16x32_bf16 v[80:83], v[100:103], a[32:35], v[80:83]
v_mul_f32 v162, v162, v160
v_mul_f32 v163, v163, v161
v_mfma_f32_16x16x32_bf16 v[84:87], v[100:103], a[36:39], v[84:87]
ds_read_b64_tr_b16 v[96:97], v8 offset:28672
ds_read_b64_tr_b16 v[98:99], v8 offset:29184
v_mfma_f32_16x16x32_bf16 v[88:91], v[100:103], a[40:43], v[88:91]
buffer_load_dwordx4 v14, s[4:7], s23 offen offset:2048 lds
v_cvt_pk_bf16_f32 v168, v162, v163
v_mfma_f32_16x16x32_bf16 v[92:95], v[100:103], a[44:47], v[92:95]
v_mul_f32 v164, v34, v34
s_waitcnt lgkmcnt(4)
v_mfma_f32_16x16x32_bf16 v[64:67], v[104:107], a[48:51], v[64:67]
v_mul_f32 v165, v35, v35
v_fma_f32 v164, v164, v120, v18
v_mfma_f32_16x16x32_bf16 v[68:71], v[104:107], a[52:55], v[68:71]
ds_read_b64_tr_b16 v[100:101], v8 offset:40960
ds_read_b64_tr_b16 v[102:103], v8 offset:41472
v_mfma_f32_16x16x32_bf16 v[72:75], v[104:107], a[56:59], v[72:75]
s_add_u32 m0, s25, 122880
v_fma_f32 v165, v165, v120, v18
buffer_load_dwordx4 v15, s[8:11], s23 offen lds
v_mfma_f32_16x16x32_bf16 v[76:79], v[104:107], a[60:63], v[76:79]
v_mul_f32 v164, v164, v34
s_waitcnt lgkmcnt(4)
v_mfma_f32_16x16x32_bf16 v[80:83], v[108:111], a[48:51], v[80:83]
v_mul_f32 v165, v165, v35
v_exp_f32 v164, v164
v_exp_f32 v165, v165
v_mfma_f32_16x16x32_bf16 v[84:87], v[108:111], a[52:55], v[84:87]
ds_read_b64_tr_b16 v[104:105], v8 offset:32768
ds_read_b64_tr_b16 v[106:107], v8 offset:33280
v_mfma_f32_16x16x32_bf16 v[88:91], v[108:111], a[56:59], v[88:91]
buffer_load_dwordx4 v16, s[8:11], s23 offen offset:1024 lds
v_mul_f32 v166, v34, v50
v_mfma_f32_16x16x32_bf16 v[92:95], v[108:111], a[60:63], v[92:95]
v_mul_f32 v167, v35, v51
s_waitcnt lgkmcnt(4)
v_mfma_f32_16x16x32_bf16 v[64:67], v[96:99], a[64:67], v[64:67]
v_add_f32 v164, 1.0, v164
v_add_f32 v165, 1.0, v165
v_mfma_f32_16x16x32_bf16 v[68:71], v[96:99], a[68:71], v[68:71]
ds_read_b64_tr_b16 v[108:109], v8 offset:45056
ds_read_b64_tr_b16 v[110:111], v8 offset:45568
v_mfma_f32_16x16x32_bf16 v[72:75], v[96:99], a[72:75], v[72:75]
buffer_load_dwordx4 v17, s[8:11], s23 offen offset:2048 lds
v_rcp_f32 v164, v164
v_mfma_f32_16x16x32_bf16 v[76:79], v[96:99], a[76:79], v[76:79]
v_rcp_f32 v165, v165
s_waitcnt lgkmcnt(4)
v_mfma_f32_16x16x32_bf16 v[80:83], v[100:103], a[64:67], v[80:83]
v_mul_f32 v166, v166, v164
v_mul_f32 v167, v167, v165
v_cvt_pk_bf16_f32 v169, v166, v167
v_mfma_f32_16x16x32_bf16 v[84:87], v[100:103], a[68:71], v[84:87]
s_waitcnt vmcnt(12) lgkmcnt(0)
s_barrier
v_mfma_f32_16x16x32_bf16 v[88:91], v[100:103], a[72:75], v[88:91]
ds_read_b64_tr_b16 v[96:97], v8 offset:49152
ds_read_b64_tr_b16 v[98:99], v8 offset:49664
s_add_u32 s23, s23, s32
s_add_u32 m0, s24, 0
v_mul_f32 v160, v36, v36
buffer_load_dwordx4 v12, s[4:7], s23 offen lds
v_mfma_f32_16x16x32_bf16 v[92:95], v[100:103], a[76:79], v[92:95]
v_mul_f32 v161, v37, v37
v_mfma_f32_16x16x32_bf16 v[64:67], v[104:107], a[80:83], v[64:67]
v_fma_f32 v160, v160, v121, v21
v_fma_f32 v161, v161, v121, v21
v_mfma_f32_16x16x32_bf16 v[68:71], v[104:107], a[84:87], v[68:71]
ds_read_b64_tr_b16 v[100:101], v8 offset:61440
ds_read_b64_tr_b16 v[102:103], v8 offset:61952
v_mfma_f32_16x16x32_bf16 v[72:75], v[104:107], a[88:91], v[72:75]
buffer_load_dwordx4 v13, s[4:7], s23 offen offset:1024 lds
v_mul_f32 v160, v160, v36
v_mfma_f32_16x16x32_bf16 v[76:79], v[104:107], a[92:95], v[76:79]
v_mul_f32 v161, v161, v37
v_mfma_f32_16x16x32_bf16 v[80:83], v[108:111], a[80:83], v[80:83]
v_exp_f32 v160, v160
v_exp_f32 v161, v161
v_mfma_f32_16x16x32_bf16 v[84:87], v[108:111], a[84:87], v[84:87]
ds_read_b64_tr_b16 v[104:105], v8 offset:53248
ds_read_b64_tr_b16 v[106:107], v8 offset:53760
v_mfma_f32_16x16x32_bf16 v[88:91], v[108:111], a[88:91], v[88:91]
buffer_load_dwordx4 v14, s[4:7], s23 offen offset:2048 lds
v_mul_f32 v162, v36, v52
v_mfma_f32_16x16x32_bf16 v[92:95], v[108:111], a[92:95], v[92:95]
v_mul_f32 v163, v37, v53
s_waitcnt lgkmcnt(4)
v_mfma_f32_16x16x32_bf16 v[64:67], v[96:99], a[96:99], v[64:67]
v_add_f32 v160, 1.0, v160
v_add_f32 v161, 1.0, v161
v_rcp_f32 v160, v160
v_mfma_f32_16x16x32_bf16 v[68:71], v[96:99], a[100:103], v[68:71]
ds_read_b64_tr_b16 v[108:109], v30 offset:0
ds_read_b64_tr_b16 v[110:111], v30 offset:512
v_mfma_f32_16x16x32_bf16 v[72:75], v[96:99], a[104:107], v[72:75]
s_add_u32 m0, s25, 0
v_rcp_f32 v161, v161
buffer_load_dwordx4 v15, s[8:11], s23 offen lds
v_mfma_f32_16x16x32_bf16 v[76:79], v[96:99], a[108:111], v[76:79]
v_mul_f32 v162, v162, v160
s_waitcnt lgkmcnt(4)
v_mfma_f32_16x16x32_bf16 v[80:83], v[100:103], a[96:99], v[80:83]
v_mul_f32 v163, v163, v161
v_cvt_pk_bf16_f32 v170, v162, v163
v_mfma_f32_16x16x32_bf16 v[84:87], v[100:103], a[100:103], v[84:87]
ds_read_b64_tr_b16 v[96:97], v8 offset:57344
ds_read_b64_tr_b16 v[98:99], v8 offset:57856
v_mfma_f32_16x16x32_bf16 v[88:91], v[100:103], a[104:107], v[88:91]
buffer_load_dwordx4 v16, s[8:11], s23 offen offset:1024 lds
v_mul_f32 v164, v38, v38
v_mfma_f32_16x16x32_bf16 v[92:95], v[100:103], a[108:111], v[92:95]
v_mul_f32 v165, v39, v39
s_waitcnt lgkmcnt(4)
v_mfma_f32_16x16x32_bf16 v[64:67], v[104:107], a[112:115], v[64:67]
v_fma_f32 v164, v164, v121, v21
v_fma_f32 v165, v165, v121, v21
v_mul_f32 v164, v164, v38
v_mfma_f32_16x16x32_bf16 v[68:71], v[104:107], a[116:119], v[68:71]
ds_read_b64_tr_b16 v[100:101], v30 offset:4096
ds_read_b64_tr_b16 v[102:103], v30 offset:4608
v_mfma_f32_16x16x32_bf16 v[72:75], v[104:107], a[120:123], v[72:75]
buffer_load_dwordx4 v17, s[8:11], s23 offen offset:2048 lds
v_mul_f32 v165, v165, v39
v_mfma_f32_16x16x32_bf16 v[76:79], v[104:107], a[124:127], v[76:79]
v_exp_f32 v164, v164
s_waitcnt lgkmcnt(4)
v_mfma_f32_16x16x32_bf16 v[80:83], v[108:111], a[112:115], v[80:83]
v_exp_f32 v165, v165
v_mul_f32 v166, v38, v54
v_mfma_f32_16x16x32_bf16 v[84:87], v[108:111], a[116:119], v[84:87]
ds_read_b64_tr_b16 v[104:105], v30 offset:8192
ds_read_b64_tr_b16 v[106:107], v30 offset:8704
v_mfma_f32_16x16x32_bf16 v[88:91], v[108:111], a[120:123], v[88:91]
s_add_u32 s23, s23, s31
s_add_u32 m0, s24, 24576
v_mul_f32 v167, v39, v55
buffer_load_dwordx4 v12, s[4:7], s23 offen lds
v_mfma_f32_16x16x32_bf16 v[92:95], v[108:111], a[124:127], v[92:95]
v_add_f32 v164, 1.0, v164
s_waitcnt lgkmcnt(4)
v_mfma_f32_16x16x32_bf16 v[64:67], v[96:99], a[128:131], v[64:67]
v_add_f32 v165, 1.0, v165
v_rcp_f32 v164, v164
v_mfma_f32_16x16x32_bf16 v[68:71], v[96:99], a[132:135], v[68:71]
ds_read_b64_tr_b16 v[108:109], v30 offset:20480
ds_read_b64_tr_b16 v[110:111], v30 offset:20992
v_mfma_f32_16x16x32_bf16 v[72:75], v[96:99], a[136:139], v[72:75]
buffer_load_dwordx4 v13, s[4:7], s23 offen offset:1024 lds
v_rcp_f32 v165, v165
v_mfma_f32_16x16x32_bf16 v[76:79], v[96:99], a[140:143], v[76:79]
v_mul_f32 v166, v166, v164
s_waitcnt lgkmcnt(4)
v_mfma_f32_16x16x32_bf16 v[80:83], v[100:103], a[128:131], v[80:83]
v_mul_f32 v167, v167, v165
v_cvt_pk_bf16_f32 v171, v166, v167
v_mul_f32 v160, v40, v40
v_mfma_f32_16x16x32_bf16 v[84:87], v[100:103], a[132:135], v[84:87]
ds_read_b64_tr_b16 v[96:97], v30 offset:12288
ds_read_b64_tr_b16 v[98:99], v30 offset:12800
v_mfma_f32_16x16x32_bf16 v[88:91], v[100:103], a[136:139], v[88:91]
buffer_load_dwordx4 v14, s[4:7], s23 offen offset:2048 lds
v_mul_f32 v161, v41, v41
v_mfma_f32_16x16x32_bf16 v[92:95], v[100:103], a[140:143], v[92:95]
v_fma_f32 v160, v160, v122, v22
s_waitcnt lgkmcnt(4)
v_mfma_f32_16x16x32_bf16 v[64:67], v[104:107], a[144:147], v[64:67]
v_fma_f32 v161, v161, v122, v22
v_mul_f32 v160, v160, v40
v_mfma_f32_16x16x32_bf16 v[68:71], v[104:107], a[148:151], v[68:71]
ds_read_b64_tr_b16 v[100:101], v30 offset:24576
ds_read_b64_tr_b16 v[102:103], v30 offset:25088
v_mfma_f32_16x16x32_bf16 v[72:75], v[104:107], a[152:155], v[72:75]
s_add_u32 m0, s25, 24576
v_mul_f32 v161, v161, v41
buffer_load_dwordx4 v15, s[8:11], s23 offen lds
v_mfma_f32_16x16x32_bf16 v[76:79], v[104:107], a[156:159], v[76:79]
v_exp_f32 v160, v160
s_waitcnt lgkmcnt(4)
v_mfma_f32_16x16x32_bf16 v[80:83], v[108:111], a[144:147], v[80:83]
v_exp_f32 v161, v161
v_mul_f32 v162, v40, v56
v_mfma_f32_16x16x32_bf16 v[84:87], v[108:111], a[148:151], v[84:87]
ds_read_b64_tr_b16 v[104:105], v30 offset:16384
ds_read_b64_tr_b16 v[106:107], v30 offset:16896
v_mfma_f32_16x16x32_bf16 v[88:91], v[108:111], a[152:155], v[88:91]
buffer_load_dwordx4 v16, s[8:11], s23 offen offset:1024 lds
v_mul_f32 v163, v41, v57
v_mfma_f32_16x16x32_bf16 v[92:95], v[108:111], a[156:159], v[92:95]
v_add_f32 v160, 1.0, v160
s_waitcnt lgkmcnt(4)
v_mfma_f32_16x16x32_bf16 v[64:67], v[96:99], a[160:163], v[64:67]
v_add_f32 v161, 1.0, v161
v_rcp_f32 v160, v160
v_rcp_f32 v161, v161
v_mfma_f32_16x16x32_bf16 v[68:71], v[96:99], a[164:167], v[68:71]
ds_read_b64_tr_b16 v[108:109], v30 offset:28672
ds_read_b64_tr_b16 v[110:111], v30 offset:29184
v_mfma_f32_16x16x32_bf16 v[72:75], v[96:99], a[168:171], v[72:75]
buffer_load_dwordx4 v17, s[8:11], s23 offen offset:2048 lds
v_mul_f32 v162, v162, v160
v_mfma_f32_16x16x32_bf16 v[76:79], v[96:99], a[172:175], v[76:79]
s_sub_u32 s63, s63, 1
s_cmp_lg_u32 s63, -1
s_cbranch_scc1 L_nopfA
buffer_load_dword v252, v11, s[80:83], s26 offen
buffer_load_dword v253, v28, s[84:87], s26 offen
L_nopfA:
v_mul_f32 v163, v163, v161
s_waitcnt lgkmcnt(4)
v_mfma_f32_16x16x32_bf16 v[80:83], v[100:103], a[160:163], v[80:83]
v_cvt_pk_bf16_f32 v172, v162, v163
v_mul_f32 v164, v42, v42
v_mfma_f32_16x16x32_bf16 v[84:87], v[100:103], a[164:167], v[84:87]
s_waitcnt vmcnt(12) lgkmcnt(0)
s_barrier
v_mfma_f32_16x16x32_bf16 v[88:91], v[100:103], a[168:171], v[88:91]
ds_read_b64_tr_b16 v[96:97], v30 offset:32768
ds_read_b64_tr_b16 v[98:99], v30 offset:33280
s_add_u32 s23, s23, s31
s_add_u32 m0, s24, 49152
v_mul_f32 v165, v43, v43
buffer_load_dwordx4 v12, s[4:7], s23 offen lds
v_mfma_f32_16x16x32_bf16 v[92:95], v[100:103], a[172:175], v[92:95]
v_fma_f32 v164, v164, v122, v22
v_mfma_f32_16x16x32_bf16 v[64:67], v[104:107], a[176:179], v[64:67]
v_fma_f32 v165, v165, v122, v22
v_mul_f32 v164, v164, v42
v_mul_f32 v165, v165, v43
v_mfma_f32_16x16x32_bf16 v[68:71], v[104:107], a[180:183], v[68:71]
ds_read_b64_tr_b16 v[100:101], v30 offset:45056
ds_read_b64_tr_b16 v[102:103], v30 offset:45568
v_mfma_f32_16x16x32_bf16 v[72:75], v[104:107], a[184:187], v[72:75]
buffer_load_dwordx4 v13, s[4:7], s23 offen offset:1024 lds
v_exp_f32 v164, v164
v_mfma_f32_16x16x32_bf16 v[76:79], v[104:107], a[188:191], v[76:79]
v_exp_f32 v165, v165
v_mfma_f32_16x16x32_bf16 v[80:83], v[108:111], a[176:179], v[80:83]
v_mul_f32 v166, v42, v58
v_mul_f32 v167, v43, v59
v_mfma_f32_16x16x32_bf16 v[84:87], v[108:111], a[180:183], v[84:87]
ds_read_b64_tr_b16 v[104:105], v30 offset:36864
ds_read_b64_tr_b16 v[106:107], v30 offset:37376
v_mfma_f32_16x16x32_bf16 v[88:91], v[108:111], a[184:187], v[88:91]
buffer_load_dwordx4 v14, s[4:7], s23 offen offset:2048 lds
v_add_f32 v164, 1.0, v164
v_mfma_f32_16x16x32_bf16 v[92:95], v[108:111], a[188:191], v[92:95]
v_add_f32 v165, 1.0, v165
s_waitcnt lgkmcnt(4)
v_mfma_f32_16x16x32_bf16 v[64:67], v[96:99], a[192:195], v[64:67]
v_rcp_f32 v164, v164
v_rcp_f32 v165, v165
v_mfma_f32_16x16x32_bf16 v[68:71], v[96:99], a[196:199], v[68:71]
ds_read_b64_tr_b16 v[108:109], v30 offset:49152
ds_read_b64_tr_b16 v[110:111], v30 offset:49664
v_mfma_f32_16x16x32_bf16 v[72:75], v[96:99], a[200:203], v[72:75]
s_add_u32 m0, s25, 49152
v_mul_f32 v166, v166, v164
buffer_load_dwordx4 v15, s[8:11], s23 offen lds
v_mfma_f32_16x16x32_bf16 v[76:79], v[96:99], a[204:207], v[76:79]
v_mul_f32 v167, v167, v165
s_waitcnt lgkmcnt(4)
v_mfma_f32_16x16x32_bf16 v[80:83], v[100:103], a[192:195], v[80:83]
v_cvt_pk_bf16_f32 v173, v166, v167
v_mul_f32 v160, v44, v44
v_mul_f32 v161, v45, v45
v_mfma_f32_16x16x32_bf16 v[84:87], v[100:103], a[196:199], v[84:87]
ds_read_b64_tr_b16 v[96:97], v30 offset:40960
ds_read_b64_tr_b16 v[98:99], v30 offset:41472
v_mfma_f32_16x16x32_bf16 v[88:91], v[100:103], a[200:203], v[88:91]
buffer_load_dwordx4 v16, s[8:11], s23 offen offset:1024 lds
v_fma_f32 v160, v160, v123, v23
v_mfma_f32_16x16x32_bf16 v[92:95], v[100:103], a[204:207], v[92:95]
v_fma_f32 v161, v161, v123, v23
s_waitcnt lgkmcnt(4)
v_mfma_f32_16x16x32_bf16 v[64:67], v[104:107], a[208:211], v[64:67]
v_mul_f32 v160, v160, v44
v_mul_f32 v161, v161, v45
v_mfma_f32_16x16x32_bf16 v[68:71], v[104:107], a[212:215], v[68:71]
ds_read_b64_tr_b16 v[100:101], v30 offset:53248
ds_read_b64_tr_b16 v[102:103], v30 offset:53760
v_mfma_f32_16x16x32_bf16 v[72:75], v[104:107], a[216:219], v[72:75]
buffer_load_dwordx4 v17, s[8:11], s23 offen offset:2048 lds
v_exp_f32 v160, v160
v_mfma_f32_16x16x32_bf16 v[76:79], v[104:107], a[220:223], v[76:79]
v_exp_f32 v161, v161
s_waitcnt lgkmcnt(4)
v_mfma_f32_16x16x32_bf16 v[80:83], v[108:111], a[208:211], v[80:83]
v_mul_f32 v162, v44, v60
v_mul_f32 v163, v45, v61
v_add_f32 v160, 1.0, v160
v_mfma_f32_16x16x32_bf16 v[84:87], v[108:111], a[212:215], v[84:87]
ds_read_b64_tr_b16 v[104:105], v30 offset:57344
ds_read_b64_tr_b16 v[106:107], v30 offset:57856
v_mfma_f32_16x16x32_bf16 v[88:91], v[108:111], a[216:219], v[88:91]
s_add_u32 s23, s23, s31
s_add_u32 m0, s24, 73728
v_add_f32 v161, 1.0, v161
buffer_load_dwordx4 v12, s[4:7], s23 offen lds
v_mfma_f32_16x16x32_bf16 v[92:95], v[108:111], a[220:223], v[92:95]
v_rcp_f32 v160, v160
s_waitcnt lgkmcnt(4)
v_mfma_f32_16x16x32_bf16 v[64:67], v[96:99], a[224:227], v[64:67]
v_rcp_f32 v161, v161
v_mul_f32 v162, v162, v160
v_mfma_f32_16x16x32_bf16 v[68:71], v[96:99], a[228:231], v[68:71]
ds_read_b64_tr_b16 v[108:109], v31 offset:4096
ds_read_b64_tr_b16 v[110:111], v31 offset:4608
v_mfma_f32_16x16x32_bf16 v[72:75], v[96:99], a[232:235], v[72:75]
buffer_load_dwordx4 v13, s[4:7], s23 offen offset:1024 lds
v_mul_f32 v163, v163, v161
v_mfma_f32_16x16x32_bf16 v[76:79], v[96:99], a[236:239], v[76:79]
v_cvt_pk_bf16_f32 v174, v162, v163
s_waitcnt lgkmcnt(4)
v_mfma_f32_16x16x32_bf16 v[80:83], v[100:103], a[224:227], v[80:83]
v_mul_f32 v164, v46, v46
v_mul_f32 v165, v47, v47
v_mfma_f32_16x16x32_bf16 v[84:87], v[100:103], a[228:231], v[84:87]
ds_read_b64_tr_b16 v[96:97], v30 offset:61440
ds_read_b64_tr_b16 v[98:99], v30 offset:61952
v_mfma_f32_16x16x32_bf16 v[88:91], v[100:103], a[232:235], v[88:91]
buffer_load_dwordx4 v14, s[4:7], s23 offen offset:2048 lds
v_fma_f32 v164, v164, v123, v23
v_mfma_f32_16x16x32_bf16 v[92:95], v[100:103], a[236:239], v[92:95]
v_fma_f32 v165, v165, v123, v23
s_waitcnt lgkmcnt(4)
v_mfma_f32_16x16x32_bf16 v[64:67], v[104:107], a[240:243], v[64:67]
v_mul_f32 v164, v164, v46
v_mul_f32 v165, v165, v47
v_exp_f32 v164, v164
v_mfma_f32_16x16x32_bf16 v[68:71], v[104:107], a[244:247], v[68:71]
ds_read_b64_tr_b16 v[100:101], v31 offset:8192
ds_read_b64_tr_b16 v[102:103], v31 offset:8704
v_mfma_f32_16x16x32_bf16 v[72:75], v[104:107], a[248:251], v[72:75]
s_add_u32 m0, s25, 73728
v_exp_f32 v165, v165
buffer_load_dwordx4 v15, s[8:11], s23 offen lds
v_mfma_f32_16x16x32_bf16 v[76:79], v[104:107], a[252:255], v[76:79]
v_mul_f32 v166, v46, v62
s_waitcnt lgkmcnt(4)
v_mfma_f32_16x16x32_bf16 v[80:83], v[108:111], a[240:243], v[80:83]
v_mul_f32 v167, v47, v63
v_add_f32 v164, 1.0, v164
v_mfma_f32_16x16x32_bf16 v[84:87], v[108:111], a[244:247], v[84:87]
ds_read_b64_tr_b16 v[104:105], v31 offset:0
ds_read_b64_tr_b16 v[106:107], v31 offset:512
v_mfma_f32_16x16x32_bf16 v[88:91], v[108:111], a[248:251], v[88:91]
buffer_load_dwordx4 v16, s[8:11], s23 offen offset:1024 lds
v_add_f32 v165, 1.0, v165
v_mfma_f32_16x16x32_bf16 v[92:95], v[108:111], a[252:255], v[92:95]
v_rcp_f32 v164, v164
s_waitcnt lgkmcnt(4)
v_mfma_f32_16x16x32_bf16 v[64:67], v[96:99], v[128:131], v[64:67]
v_rcp_f32 v165, v165
v_mul_f32 v166, v166, v164
v_mfma_f32_16x16x32_bf16 v[68:71], v[96:99], v[132:135], v[68:71]
ds_read_b64_tr_b16 v[108:109], v31 offset:12288
ds_read_b64_tr_b16 v[110:111], v31 offset:12800
v_mfma_f32_16x16x32_bf16 v[72:75], v[96:99], v[136:139], v[72:75]
buffer_load_dwordx4 v17, s[8:11], s23 offen offset:2048 lds
v_mul_f32 v167, v167, v165
v_mfma_f32_16x16x32_bf16 v[76:79], v[96:99], v[140:143], v[76:79]
v_cvt_pk_bf16_f32 v175, v166, v167
s_waitcnt lgkmcnt(4)
v_mfma_f32_16x16x32_bf16 v[80:83], v[100:103], v[128:131], v[80:83]
v_mfma_f32_16x16x32_bf16 v[84:87], v[100:103], v[132:135], v[84:87]
s_waitcnt vmcnt(12) lgkmcnt(0)
s_barrier
v_mfma_f32_16x16x32_bf16 v[88:91], v[100:103], v[136:139], v[88:91]
ds_read_b64_tr_b16 v[96:97], v8 offset:0
ds_read_b64_tr_b16 v[98:99], v8 offset:512
s_add_u32 s23, s23, s31
s_set_gpr_idx_on s39, gpr_idx(DST)
s_nop 0
v_mov_b32 v176, v168
v_mov_b32 v177, v169
v_mov_b32 v178, v170
v_mov_b32 v179, v171
v_mov_b32 v180, v172
v_mov_b32 v181, v173
v_mov_b32 v182, v174
v_mov_b32 v183, v175
s_set_gpr_idx_off
s_add_u32 s39, s39, 8
s_add_u32 m0, s24, 98304
s_nop 0
buffer_load_dwordx4 v12, s[4:7], s23 offen lds
v_mfma_f32_16x16x32_bf16 v[92:95], v[100:103], v[140:143], v[92:95]
v_mfma_f32_16x16x32_bf16 v[64:67], v[104:107], v[144:147], v[64:67]
v_mfma_f32_16x16x32_bf16 v[68:71], v[104:107], v[148:151], v[68:71]
ds_read_b64_tr_b16 v[100:101], v8 offset:12288
ds_read_b64_tr_b16 v[102:103], v8 offset:12800
v_mfma_f32_16x16x32_bf16 v[72:75], v[104:107], v[152:155], v[72:75]
buffer_load_dwordx4 v13, s[4:7], s23 offen offset:1024 lds
v_mfma_f32_16x16x32_bf16 v[76:79], v[104:107], v[156:159], v[76:79]
v_mfma_f32_16x16x32_bf16 v[80:83], v[108:111], v[144:147], v[80:83]
v_mfma_f32_16x16x32_bf16 v[84:87], v[108:111], v[148:151], v[84:87]
ds_read_b64_tr_b16 v[104:105], v8 offset:4096
ds_read_b64_tr_b16 v[106:107], v8 offset:4608
v_mfma_f32_16x16x32_bf16 v[88:91], v[108:111], v[152:155], v[88:91]
buffer_load_dwordx4 v14, s[4:7], s23 offen offset:2048 lds
v_mfma_f32_16x16x32_bf16 v[92:95], v[108:111], v[156:159], v[92:95]
L_roundB:
s_waitcnt lgkmcnt(4)
v_mfma_f32_16x16x32_bf16 v[32:35], v[96:99], a[0:3], 0
v_mfma_f32_16x16x32_bf16 v[36:39], v[96:99], a[4:7], 0
ds_read_b64_tr_b16 v[108:109], v8 offset:16384
ds_read_b64_tr_b16 v[110:111], v8 offset:16896
v_mfma_f32_16x16x32_bf16 v[40:43], v[96:99], a[8:11], 0
s_add_u32 m0, s25, 98304
s_nop 0
buffer_load_dwordx4 v15, s[8:11], s23 offen lds
v_mfma_f32_16x16x32_bf16 v[44:47], v[96:99], a[12:15], 0
s_waitcnt lgkmcnt(4)
v_mfma_f32_16x16x32_bf16 v[48:51], v[100:103], a[0:3], 0
v_mfma_f32_16x16x32_bf16 v[52:55], v[100:103], a[4:7], 0
ds_read_b64_tr_b16 v[96:97], v8 offset:8192
ds_read_b64_tr_b16 v[98:99], v8 offset:8704
v_mfma_f32_16x16x32_bf16 v[56:59], v[100:103], a[8:11], 0
buffer_load_dwordx4 v16, s[8:11], s23 offen offset:1024 lds
v_mfma_f32_16x16x32_bf16 v[60:63], v[100:103], a[12:15], 0
s_waitcnt lgkmcnt(4)
v_mfma_f32_16x16x32_bf16 v[32:35], v[104:107], a[16:19], v[32:35]
v_mul_f32 v160, v64, v64
v_mul_f32 v161, v65, v65
v_fma_f32 v160, v160, v120, v18
v_mfma_f32_16x16x32_bf16 v[36:39], v[104:107], a[20:23], v[36:39]
ds_read_b64_tr_b16 v[100:101], v8 offset:20480
ds_read_b64_tr_b16 v[102:103], v8 offset:20992
v_mfma_f32_16x16x32_bf16 v[40:43], v[104:107], a[24:27], v[40:43]
buffer_load_dwordx4 v17, s[8:11], s23 offen offset:2048 lds
v_fma_f32 v161, v161, v120, v18
v_mfma_f32_16x16x32_bf16 v[44:47], v[104:107], a[28:31], v[44:47]
v_mul_f32 v160, v160, v64
s_waitcnt lgkmcnt(4)
v_mfma_f32_16x16x32_bf16 v[48:51], v[108:111], a[16:19], v[48:51]
v_mul_f32 v161, v161, v65
v_exp_f32 v160, v160
v_mfma_f32_16x16x32_bf16 v[52:55], v[108:111], a[20:23], v[52:55]
ds_read_b64_tr_b16 v[104:105], v8 offset:24576
ds_read_b64_tr_b16 v[106:107], v8 offset:25088
v_mfma_f32_16x16x32_bf16 v[56:59], v[108:111], a[24:27], v[56:59]
s_add_u32 s23, s23, s31
s_add_u32 m0, s24, 122880
v_exp_f32 v161, v161
buffer_load_dwordx4 v12, s[4:7], s23 offen lds
v_mfma_f32_16x16x32_bf16 v[60:63], v[108:111], a[28:31], v[60:63]
v_mul_f32 v162, v64, v80
s_waitcnt lgkmcnt(4)
v_mfma_f32_16x16x32_bf16 v[32:35], v[96:99], a[32:35], v[32:35]
v_mul_f32 v163, v65, v81
v_add_f32 v160, 1.0, v160
v_add_f32 v161, 1.0, v161
v_mfma_f32_16x16x32_bf16 v[36:39], v[96:99], a[36:39], v[36:39]
ds_read_b64_tr_b16 v[108:109], v8 offset:36864
ds_read_b64_tr_b16 v[110:111], v8 offset:37376
v_mfma_f32_16x16x32_bf16 v[40:43], v[96:99], a[40:43], v[40:43]
buffer_load_dwordx4 v13, s[4:7], s23 offen offset:1024 lds
v_rcp_f32 v160, v160
v_mfma_f32_16x16x32_bf16 v[44:47], v[96:99], a[44:47], v[44:47]
v_rcp_f32 v161, v161
s_waitcnt lgkmcnt(4)
v_mfma_f32_16x16x32_bf16 v[48:51], v[100:103], a[32:35], v[48:51]
v_mul_f32 v162, v162, v160
v_mul_f32 v163, v163, v161
v_mfma_f32_16x16x32_bf16 v[52:55], v[100:103], a[36:39], v[52:55]
ds_read_b64_tr_b16 v[96:97], v8 offset:28672
ds_read_b64_tr_b16 v[98:99], v8 offset:29184
v_mfma_f32_16x16x32_bf16 v[56:59], v[100:103], a[40:43], v[56:59]
buffer_load_dwordx4 v14, s[4:7], s23 offen offset:2048 lds
v_cvt_pk_bf16_f32 v168, v162, v163
v_mfma_f32_16x16x32_bf16 v[60:63], v[100:103], a[44:47], v[60:63]
v_mul_f32 v164, v66, v66
s_waitcnt lgkmcnt(4)
v_mfma_f32_16x16x32_bf16 v[32:35], v[104:107], a[48:51], v[32:35]
v_mul_f32 v165, v67, v67
v_fma_f32 v164, v164, v120, v18
v_mfma_f32_16x16x32_bf16 v[36:39], v[104:107], a[52:55], v[36:39]
ds_read_b64_tr_b16 v[100:101], v8 offset:40960
ds_read_b64_tr_b16 v[102:103], v8 offset:41472
v_mfma_f32_16x16x32_bf16 v[40:43], v[104:107], a[56:59], v[40:43]
s_add_u32 m0, s25, 122880
v_fma_f32 v165, v165, v120, v18
buffer_load_dwordx4 v15, s[8:11], s23 offen lds
v_mfma_f32_16x16x32_bf16 v[44:47], v[104:107], a[60:63], v[44:47]
v_mul_f32 v164, v164, v66
s_waitcnt lgkmcnt(4)
v_mfma_f32_16x16x32_bf16 v[48:51], v[108:111], a[48:51], v[48:51]
v_mul_f32 v165, v165, v67
v_exp_f32 v164, v164
v_exp_f32 v165, v165
v_mfma_f32_16x16x32_bf16 v[52:55], v[108:111], a[52:55], v[52:55]
ds_read_b64_tr_b16 v[104:105], v8 offset:32768
ds_read_b64_tr_b16 v[106:107], v8 offset:33280
v_mfma_f32_16x16x32_bf16 v[56:59], v[108:111], a[56:59], v[56:59]
buffer_load_dwordx4 v16, s[8:11], s23 offen offset:1024 lds
v_mul_f32 v166, v66, v82
v_mfma_f32_16x16x32_bf16 v[60:63], v[108:111], a[60:63], v[60:63]
v_mul_f32 v167, v67, v83
s_waitcnt lgkmcnt(4)
v_mfma_f32_16x16x32_bf16 v[32:35], v[96:99], a[64:67], v[32:35]
v_add_f32 v164, 1.0, v164
v_add_f32 v165, 1.0, v165
v_mfma_f32_16x16x32_bf16 v[36:39], v[96:99], a[68:71], v[36:39]
ds_read_b64_tr_b16 v[108:109], v8 offset:45056
ds_read_b64_tr_b16 v[110:111], v8 offset:45568
v_mfma_f32_16x16x32_bf16 v[40:43], v[96:99], a[72:75], v[40:43]
buffer_load_dwordx4 v17, s[8:11], s23 offen offset:2048 lds
v_rcp_f32 v164, v164
v_mfma_f32_16x16x32_bf16 v[44:47], v[96:99], a[76:79], v[44:47]
v_rcp_f32 v165, v165
s_waitcnt lgkmcnt(4)
v_mfma_f32_16x16x32_bf16 v[48:51], v[100:103], a[64:67], v[48:51]
v_mul_f32 v166, v166, v164
v_mul_f32 v167, v167, v165
v_cvt_pk_bf16_f32 v169, v166, v167
v_mfma_f32_16x16x32_bf16 v[52:55], v[100:103], a[68:71], v[52:55]
s_waitcnt vmcnt(12) lgkmcnt(0)
s_barrier
v_mfma_f32_16x16x32_bf16 v[56:59], v[100:103], a[72:75], v[56:59]
ds_read_b64_tr_b16 v[96:97], v8 offset:49152
ds_read_b64_tr_b16 v[98:99], v8 offset:49664
s_cmp_lg_u32 s30, 0
s_cbranch_scc1 L_nosw
s_mov_b32 s4, s16
s_mov_b32 s5, s17
s_mov_b32 s8, s16
s_mov_b32 s9, s17
s_mul_i32 s34, s20, 55296
s_sub_u32 s35, 110592, s34
v_subrev_u32 v12, s34, v24
v_add_u32 v15, s35, v24
v_subrev_u32 v13, s34, v25
v_add_u32 v16, s35, v25
v_subrev_u32 v14, s34, v26
v_add_u32 v17, s35, v26
s_mul_i32 s23, s21, 663552
s_mov_b32 s32, 0
s_mov_b32 s31, 221184
L_nosw:
s_add_u32 s23, s23, s32
s_add_u32 m0, s24, 0
v_mul_f32 v160, v68, v68
buffer_load_dwordx4 v12, s[4:7], s23 offen lds
v_mfma_f32_16x16x32_bf16 v[60:63], v[100:103], a[76:79], v[60:63]
v_mul_f32 v161, v69, v69
v_mfma_f32_16x16x32_bf16 v[32:35], v[104:107], a[80:83], v[32:35]
v_fma_f32 v160, v160, v121, v21
v_fma_f32 v161, v161, v121, v21
v_mfma_f32_16x16x32_bf16 v[36:39], v[104:107], a[84:87], v[36:39]
ds_read_b64_tr_b16 v[100:101], v8 offset:61440
ds_read_b64_tr_b16 v[102:103], v8 offset:61952
v_mfma_f32_16x16x32_bf16 v[40:43], v[104:107], a[88:91], v[40:43]
buffer_load_dwordx4 v13, s[4:7], s23 offen offset:1024 lds
v_mul_f32 v160, v160, v68
v_mfma_f32_16x16x32_bf16 v[44:47], v[104:107], a[92:95], v[44:47]
v_mul_f32 v161, v161, v69
v_mfma_f32_16x16x32_bf16 v[48:51], v[108:111], a[80:83], v[48:51]
v_exp_f32 v160, v160
v_exp_f32 v161, v161
v_mfma_f32_16x16x32_bf16 v[52:55], v[108:111], a[84:87], v[52:55]
ds_read_b64_tr_b16 v[104:105], v8 offset:53248
ds_read_b64_tr_b16 v[106:107], v8 offset:53760
v_mfma_f32_16x16x32_bf16 v[56:59], v[108:111], a[88:91], v[56:59]
buffer_load_dwordx4 v14, s[4:7], s23 offen offset:2048 lds
v_mul_f32 v162, v68, v84
v_mfma_f32_16x16x32_bf16 v[60:63], v[108:111], a[92:95], v[60:63]
v_mul_f32 v163, v69, v85
s_waitcnt lgkmcnt(4)
v_mfma_f32_16x16x32_bf16 v[32:35], v[96:99], a[96:99], v[32:35]
v_add_f32 v160, 1.0, v160
v_add_f32 v161, 1.0, v161
v_rcp_f32 v160, v160
v_mfma_f32_16x16x32_bf16 v[36:39], v[96:99], a[100:103], v[36:39]
ds_read_b64_tr_b16 v[108:109], v30 offset:0
ds_read_b64_tr_b16 v[110:111], v30 offset:512
v_mfma_f32_16x16x32_bf16 v[40:43], v[96:99], a[104:107], v[40:43]
s_add_u32 m0, s25, 0
v_rcp_f32 v161, v161
buffer_load_dwordx4 v15, s[8:11], s23 offen lds
v_mfma_f32_16x16x32_bf16 v[44:47], v[96:99], a[108:111], v[44:47]
v_mul_f32 v162, v162, v160
s_waitcnt lgkmcnt(4)
v_mfma_f32_16x16x32_bf16 v[48:51], v[100:103], a[96:99], v[48:51]
v_mul_f32 v163, v163, v161
v_cvt_pk_bf16_f32 v170, v162, v163
v_mfma_f32_16x16x32_bf16 v[52:55], v[100:103], a[100:103], v[52:55]
ds_read_b64_tr_b16 v[96:97], v8 offset:57344
ds_read_b64_tr_b16 v[98:99], v8 offset:57856
v_mfma_f32_16x16x32_bf16 v[56:59], v[100:103], a[104:107], v[56:59]
buffer_load_dwordx4 v16, s[8:11], s23 offen offset:1024 lds
v_mul_f32 v164, v70, v70
v_mfma_f32_16x16x32_bf16 v[60:63], v[100:103], a[108:111], v[60:63]
v_mul_f32 v165, v71, v71
s_waitcnt lgkmcnt(4)
v_mfma_f32_16x16x32_bf16 v[32:35], v[104:107], a[112:115], v[32:35]
v_fma_f32 v164, v164, v121, v21
v_fma_f32 v165, v165, v121, v21
v_mul_f32 v164, v164, v70
v_mfma_f32_16x16x32_bf16 v[36:39], v[104:107], a[116:119], v[36:39]
ds_read_b64_tr_b16 v[100:101], v30 offset:4096
ds_read_b64_tr_b16 v[102:103], v30 offset:4608
v_mfma_f32_16x16x32_bf16 v[40:43], v[104:107], a[120:123], v[40:43]
buffer_load_dwordx4 v17, s[8:11], s23 offen offset:2048 lds
v_mul_f32 v165, v165, v71
v_mfma_f32_16x16x32_bf16 v[44:47], v[104:107], a[124:127], v[44:47]
v_exp_f32 v164, v164
s_waitcnt lgkmcnt(4)
v_mfma_f32_16x16x32_bf16 v[48:51], v[108:111], a[112:115], v[48:51]
v_exp_f32 v165, v165
v_mul_f32 v166, v70, v86
v_mfma_f32_16x16x32_bf16 v[52:55], v[108:111], a[116:119], v[52:55]
ds_read_b64_tr_b16 v[104:105], v30 offset:8192
ds_read_b64_tr_b16 v[106:107], v30 offset:8704
v_mfma_f32_16x16x32_bf16 v[56:59], v[108:111], a[120:123], v[56:59]
s_add_u32 s23, s23, s31
s_add_u32 m0, s24, 24576
v_mul_f32 v167, v71, v87
buffer_load_dwordx4 v12, s[4:7], s23 offen lds
v_mfma_f32_16x16x32_bf16 v[60:63], v[108:111], a[124:127], v[60:63]
v_add_f32 v164, 1.0, v164
s_waitcnt lgkmcnt(4)
v_mfma_f32_16x16x32_bf16 v[32:35], v[96:99], a[128:131], v[32:35]
v_add_f32 v165, 1.0, v165
v_rcp_f32 v164, v164
v_mfma_f32_16x16x32_bf16 v[36:39], v[96:99], a[132:135], v[36:39]
ds_read_b64_tr_b16 v[108:109], v30 offset:20480
ds_read_b64_tr_b16 v[110:111], v30 offset:20992
v_mfma_f32_16x16x32_bf16 v[40:43], v[96:99], a[136:139], v[40:43]
buffer_load_dwordx4 v13, s[4:7], s23 offen offset:1024 lds
v_rcp_f32 v165, v165
v_mfma_f32_16x16x32_bf16 v[44:47], v[96:99], a[140:143], v[44:47]
v_mul_f32 v166, v166, v164
s_waitcnt lgkmcnt(4)
v_mfma_f32_16x16x32_bf16 v[48:51], v[100:103], a[128:131], v[48:51]
v_mul_f32 v167, v167, v165
v_cvt_pk_bf16_f32 v171, v166, v167
v_mul_f32 v160, v72, v72
v_mfma_f32_16x16x32_bf16 v[52:55], v[100:103], a[132:135], v[52:55]
ds_read_b64_tr_b16 v[96:97], v30 offset:12288
ds_read_b64_tr_b16 v[98:99], v30 offset:12800
v_mfma_f32_16x16x32_bf16 v[56:59], v[100:103], a[136:139], v[56:59]
buffer_load_dwordx4 v14, s[4:7], s23 offen offset:2048 lds
v_mul_f32 v161, v73, v73
v_mfma_f32_16x16x32_bf16 v[60:63], v[100:103], a[140:143], v[60:63]
v_fma_f32 v160, v160, v122, v22
s_waitcnt lgkmcnt(4)
v_mfma_f32_16x16x32_bf16 v[32:35], v[104:107], a[144:147], v[32:35]
v_fma_f32 v161, v161, v122, v22
v_mul_f32 v160, v160, v72
v_mfma_f32_16x16x32_bf16 v[36:39], v[104:107], a[148:151], v[36:39]
ds_read_b64_tr_b16 v[100:101], v30 offset:24576
ds_read_b64_tr_b16 v[102:103], v30 offset:25088
v_mfma_f32_16x16x32_bf16 v[40:43], v[104:107], a[152:155], v[40:43]
s_add_u32 m0, s25, 24576
v_mul_f32 v161, v161, v73
buffer_load_dwordx4 v15, s[8:11], s23 offen lds
v_mfma_f32_16x16x32_bf16 v[44:47], v[104:107], a[156:159], v[44:47]
v_exp_f32 v160, v160
s_waitcnt lgkmcnt(4)
v_mfma_f32_16x16x32_bf16 v[48:51], v[108:111], a[144:147], v[48:51]
v_exp_f32 v161, v161
v_mul_f32 v162, v72, v88
v_mfma_f32_16x16x32_bf16 v[52:55], v[108:111], a[148:151], v[52:55]
ds_read_b64_tr_b16 v[104:105], v30 offset:16384
ds_read_b64_tr_b16 v[106:107], v30 offset:16896
v_mfma_f32_16x16x32_bf16 v[56:59], v[108:111], a[152:155], v[56:59]
buffer_load_dwordx4 v16, s[8:11], s23 offen offset:1024 lds
v_mul_f32 v163, v73, v89
v_mfma_f32_16x16x32_bf16 v[60:63], v[108:111], a[156:159], v[60:63]
v_add_f32 v160, 1.0, v160
s_waitcnt lgkmcnt(4)
v_mfma_f32_16x16x32_bf16 v[32:35], v[96:99], a[160:163], v[32:35]
v_add_f32 v161, 1.0, v161
v_rcp_f32 v160, v160
v_rcp_f32 v161, v161
v_mfma_f32_16x16x32_bf16 v[36:39], v[96:99], a[164:167], v[36:39]
ds_read_b64_tr_b16 v[108:109], v30 offset:28672
ds_read_b64_tr_b16 v[110:111], v30 offset:29184
v_mfma_f32_16x16x32_bf16 v[40:43], v[96:99], a[168:171], v[40:43]
buffer_load_dwordx4 v17, s[8:11], s23 offen offset:2048 lds
v_mul_f32 v162, v162, v160
v_mfma_f32_16x16x32_bf16 v[44:47], v[96:99], a[172:175], v[44:47]
s_sub_u32 s63, s63, 1
s_cmp_lg_u32 s63, -1
s_cbranch_scc1 L_nopfB
buffer_load_dword v252, v11, s[80:83], s26 offen
buffer_load_dword v253, v28, s[84:87], s26 offen
L_nopfB:
v_mul_f32 v163, v163, v161
s_waitcnt lgkmcnt(4)
v_mfma_f32_16x16x32_bf16 v[48:51], v[100:103], a[160:163], v[48:51]
v_cvt_pk_bf16_f32 v172, v162, v163
v_mul_f32 v164, v74, v74
v_mfma_f32_16x16x32_bf16 v[52:55], v[100:103], a[164:167], v[52:55]
s_waitcnt vmcnt(12) lgkmcnt(0)
s_barrier
v_mfma_f32_16x16x32_bf16 v[56:59], v[100:103], a[168:171], v[56:59]
ds_read_b64_tr_b16 v[96:97], v30 offset:32768
ds_read_b64_tr_b16 v[98:99], v30 offset:33280
s_add_u32 s23, s23, s31
s_add_u32 m0, s24, 49152
v_mul_f32 v165, v75, v75
buffer_load_dwordx4 v12, s[4:7], s23 offen lds
v_mfma_f32_16x16x32_bf16 v[60:63], v[100:103], a[172:175], v[60:63]
v_fma_f32 v164, v164, v122, v22
v_mfma_f32_16x16x32_bf16 v[32:35], v[104:107], a[176:179], v[32:35]
v_fma_f32 v165, v165, v122, v22
v_mul_f32 v164, v164, v74
v_mul_f32 v165, v165, v75
v_mfma_f32_16x16x32_bf16 v[36:39], v[104:107], a[180:183], v[36:39]
ds_read_b64_tr_b16 v[100:101], v30 offset:45056
ds_read_b64_tr_b16 v[102:103], v30 offset:45568
v_mfma_f32_16x16x32_bf16 v[40:43], v[104:107], a[184:187], v[40:43]
buffer_load_dwordx4 v13, s[4:7], s23 offen offset:1024 lds
v_exp_f32 v164, v164
v_mfma_f32_16x16x32_bf16 v[44:47], v[104:107], a[188:191], v[44:47]
v_exp_f32 v165, v165
v_mfma_f32_16x16x32_bf16 v[48:51], v[108:111], a[176:179], v[48:51]
v_mul_f32 v166, v74, v90
v_mul_f32 v167, v75, v91
v_mfma_f32_16x16x32_bf16 v[52:55], v[108:111], a[180:183], v[52:55]
ds_read_b64_tr_b16 v[104:105], v30 offset:36864
ds_read_b64_tr_b16 v[106:107], v30 offset:37376
v_mfma_f32_16x16x32_bf16 v[56:59], v[108:111], a[184:187], v[56:59]
buffer_load_dwordx4 v14, s[4:7], s23 offen offset:2048 lds
v_add_f32 v164, 1.0, v164
v_mfma_f32_16x16x32_bf16 v[60:63], v[108:111], a[188:191], v[60:63]
v_add_f32 v165, 1.0, v165
s_waitcnt lgkmcnt(4)
v_mfma_f32_16x16x32_bf16 v[32:35], v[96:99], a[192:195], v[32:35]
v_rcp_f32 v164, v164
v_rcp_f32 v165, v165
v_mfma_f32_16x16x32_bf16 v[36:39], v[96:99], a[196:199], v[36:39]
ds_read_b64_tr_b16 v[108:109], v30 offset:49152
ds_read_b64_tr_b16 v[110:111], v30 offset:49664
v_mfma_f32_16x16x32_bf16 v[40:43], v[96:99], a[200:203], v[40:43]
s_add_u32 m0, s25, 49152
v_mul_f32 v166, v166, v164
buffer_load_dwordx4 v15, s[8:11], s23 offen lds
v_mfma_f32_16x16x32_bf16 v[44:47], v[96:99], a[204:207], v[44:47]
v_mul_f32 v167, v167, v165
s_waitcnt lgkmcnt(4)
v_mfma_f32_16x16x32_bf16 v[48:51], v[100:103], a[192:195], v[48:51]
v_cvt_pk_bf16_f32 v173, v166, v167
v_mul_f32 v160, v76, v76
v_mul_f32 v161, v77, v77
v_mfma_f32_16x16x32_bf16 v[52:55], v[100:103], a[196:199], v[52:55]
ds_read_b64_tr_b16 v[96:97], v30 offset:40960
ds_read_b64_tr_b16 v[98:99], v30 offset:41472
v_mfma_f32_16x16x32_bf16 v[56:59], v[100:103], a[200:203], v[56:59]
buffer_load_dwordx4 v16, s[8:11], s23 offen offset:1024 lds
v_fma_f32 v160, v160, v123, v23
v_mfma_f32_16x16x32_bf16 v[60:63], v[100:103], a[204:207], v[60:63]
v_fma_f32 v161, v161, v123, v23
s_waitcnt lgkmcnt(4)
v_mfma_f32_16x16x32_bf16 v[32:35], v[104:107], a[208:211], v[32:35]
v_mul_f32 v160, v160, v76
v_mul_f32 v161, v161, v77
v_mfma_f32_16x16x32_bf16 v[36:39], v[104:107], a[212:215], v[36:39]
ds_read_b64_tr_b16 v[100:101], v30 offset:53248
ds_read_b64_tr_b16 v[102:103], v30 offset:53760
v_mfma_f32_16x16x32_bf16 v[40:43], v[104:107], a[216:219], v[40:43]
buffer_load_dwordx4 v17, s[8:11], s23 offen offset:2048 lds
v_exp_f32 v160, v160
v_mfma_f32_16x16x32_bf16 v[44:47], v[104:107], a[220:223], v[44:47]
v_exp_f32 v161, v161
s_waitcnt lgkmcnt(4)
v_mfma_f32_16x16x32_bf16 v[48:51], v[108:111], a[208:211], v[48:51]
v_mul_f32 v162, v76, v92
v_mul_f32 v163, v77, v93
v_add_f32 v160, 1.0, v160
v_mfma_f32_16x16x32_bf16 v[52:55], v[108:111], a[212:215], v[52:55]
ds_read_b64_tr_b16 v[104:105], v30 offset:57344
ds_read_b64_tr_b16 v[106:107], v30 offset:57856
v_mfma_f32_16x16x32_bf16 v[56:59], v[108:111], a[216:219], v[56:59]
s_add_u32 s23, s23, s31
s_cmp_eq_u32 s30, 0
s_cselect_b32 s6, 0, s6
s_cselect_b32 s10, 0, s10
s_add_u32 m0, s24, 73728
v_add_f32 v161, 1.0, v161
buffer_load_dwordx4 v12, s[4:7], s23 offen lds
v_mfma_f32_16x16x32_bf16 v[60:63], v[108:111], a[220:223], v[60:63]
v_rcp_f32 v160, v160
s_waitcnt lgkmcnt(4)
v_mfma_f32_16x16x32_bf16 v[32:35], v[96:99], a[224:227], v[32:35]
v_rcp_f32 v161, v161
v_mul_f32 v162, v162, v160
v_mfma_f32_16x16x32_bf16 v[36:39], v[96:99], a[228:231], v[36:39]
ds_read_b64_tr_b16 v[108:109], v31 offset:4096
ds_read_b64_tr_b16 v[110:111], v31 offset:4608
v_mfma_f32_16x16x32_bf16 v[40:43], v[96:99], a[232:235], v[40:43]
buffer_load_dwordx4 v13, s[4:7], s23 offen offset:1024 lds
v_mul_f32 v163, v163, v161
v_mfma_f32_16x16x32_bf16 v[44:47], v[96:99], a[236:239], v[44:47]
v_cvt_pk_bf16_f32 v174, v162, v163
s_waitcnt lgkmcnt(4)
v_mfma_f32_16x16x32_bf16 v[48:51], v[100:103], a[224:227], v[48:51]
v_mul_f32 v164, v78, v78
v_mul_f32 v165, v79, v79
v_mfma_f32_16x16x32_bf16 v[52:55], v[100:103], a[228:231], v[52:55]
ds_read_b64_tr_b16 v[96:97], v30 offset:61440
ds_read_b64_tr_b16 v[98:99], v30 offset:61952
v_mfma_f32_16x16x32_bf16 v[56:59], v[100:103], a[232:235], v[56:59]
buffer_load_dwordx4 v14, s[4:7], s23 offen offset:2048 lds
v_fma_f32 v164, v164, v123, v23
v_mfma_f32_16x16x32_bf16 v[60:63], v[100:103], a[236:239], v[60:63]
v_fma_f32 v165, v165, v123, v23
s_waitcnt lgkmcnt(4)
v_mfma_f32_16x16x32_bf16 v[32:35], v[104:107], a[240:243], v[32:35]
v_mul_f32 v164, v164, v78
v_mul_f32 v165, v165, v79
v_exp_f32 v164, v164
v_mfma_f32_16x16x32_bf16 v[36:39], v[104:107], a[244:247], v[36:39]
ds_read_b64_tr_b16 v[100:101], v31 offset:8192
ds_read_b64_tr_b16 v[102:103], v31 offset:8704
v_mfma_f32_16x16x32_bf16 v[40:43], v[104:107], a[248:251], v[40:43]
s_add_u32 m0, s25, 73728
v_exp_f32 v165, v165
buffer_load_dwordx4 v15, s[8:11], s23 offen lds
v_mfma_f32_16x16x32_bf16 v[44:47], v[104:107], a[252:255], v[44:47]
v_mul_f32 v166, v78, v94
s_waitcnt lgkmcnt(4)
v_mfma_f32_16x16x32_bf16 v[48:51], v[108:111], a[240:243], v[48:51]
v_mul_f32 v167, v79, v95
v_add_f32 v164, 1.0, v164
v_mfma_f32_16x16x32_bf16 v[52:55], v[108:111], a[244:247], v[52:55]
ds_read_b64_tr_b16 v[104:105], v31 offset:0
ds_read_b64_tr_b16 v[106:107], v31 offset:512
v_mfma_f32_16x16x32_bf16 v[56:59], v[108:111], a[248:251], v[56:59]
buffer_load_dwordx4 v16, s[8:11], s23 offen offset:1024 lds
v_add_f32 v165, 1.0, v165
v_mfma_f32_16x16x32_bf16 v[60:63], v[108:111], a[252:255], v[60:63]
v_rcp_f32 v164, v164
s_waitcnt lgkmcnt(4)
v_mfma_f32_16x16x32_bf16 v[32:35], v[96:99], v[128:131], v[32:35]
v_rcp_f32 v165, v165
v_mul_f32 v166, v166, v164
v_mfma_f32_16x16x32_bf16 v[36:39], v[96:99], v[132:135], v[36:39]
ds_read_b64_tr_b16 v[108:109], v31 offset:12288
ds_read_b64_tr_b16 v[110:111], v31 offset:12800
v_mfma_f32_16x16x32_bf16 v[40:43], v[96:99], v[136:139], v[40:43]
buffer_load_dwordx4 v17, s[8:11], s23 offen offset:2048 lds
v_mul_f32 v167, v167, v165
v_mfma_f32_16x16x32_bf16 v[44:47], v[96:99], v[140:143], v[44:47]
v_cvt_pk_bf16_f32 v175, v166, v167
s_waitcnt lgkmcnt(4)
v_mfma_f32_16x16x32_bf16 v[48:51], v[100:103], v[128:131], v[48:51]
v_mfma_f32_16x16x32_bf16 v[52:55], v[100:103], v[132:135], v[52:55]
s_waitcnt vmcnt(12) lgkmcnt(0)
s_barrier
v_mfma_f32_16x16x32_bf16 v[56:59], v[100:103], v[136:139], v[56:59]
ds_read_b64_tr_b16 v[96:97], v8 offset:0
ds_read_b64_tr_b16 v[98:99], v8 offset:512
s_add_u32 s23, s23, s31
s_set_gpr_idx_on s39, gpr_idx(DST)
s_nop 0
v_mov_b32 v176, v168
v_mov_b32 v177, v169
v_mov_b32 v178, v170
v_mov_b32 v179, v171
v_mov_b32 v180, v172
v_mov_b32 v181, v173
v_mov_b32 v182, v174
v_mov_b32 v183, v175
s_set_gpr_idx_off
s_add_u32 s39, s39, 8
s_add_u32 m0, s24, 98304
s_nop 0
buffer_load_dwordx4 v12, s[4:7], s23 offen lds
v_mfma_f32_16x16x32_bf16 v[60:63], v[100:103], v[140:143], v[60:63]
v_mfma_f32_16x16x32_bf16 v[32:35], v[104:107], v[144:147], v[32:35]
v_mfma_f32_16x16x32_bf16 v[36:39], v[104:107], v[148:151], v[36:39]
ds_read_b64_tr_b16 v[100:101], v8 offset:12288
ds_read_b64_tr_b16 v[102:103], v8 offset:12800
v_mfma_f32_16x16x32_bf16 v[40:43], v[104:107], v[152:155], v[40:43]
buffer_load_dwordx4 v13, s[4:7], s23 offen offset:1024 lds
v_mfma_f32_16x16x32_bf16 v[44:47], v[104:107], v[156:159], v[44:47]
v_mfma_f32_16x16x32_bf16 v[48:51], v[108:111], v[144:147], v[48:51]
v_mfma_f32_16x16x32_bf16 v[52:55], v[108:111], v[148:151], v[52:55]
ds_read_b64_tr_b16 v[104:105], v8 offset:4096
ds_read_b64_tr_b16 v[106:107], v8 offset:4608
v_mfma_f32_16x16x32_bf16 v[56:59], v[108:111], v[152:155], v[56:59]
buffer_load_dwordx4 v14, s[4:7], s23 offen offset:2048 lds
v_mfma_f32_16x16x32_bf16 v[60:63], v[108:111], v[156:159], v[60:63]
s_sub_u32 s30, s30, 1
s_cmp_ge_i32 s30, 0
s_cbranch_scc1 L_roundA
s_waitcnt lgkmcnt(0)
s_waitcnt vmcnt(0)
s_barrier
s_lshr_b32 s34, s20, 1
s_lshl_b32 s34, s34, 12
s_and_b32 s35, s20, 1
s_lshl_b32 s35, s35, 3
s_add_u32 s34, s34, s35
v_add_u32 v30, s34, v20
v_add_u32 v31, 32768, v30
v_mul_f32 v160, v32, v32
v_mul_f32 v161, v33, v33
v_and_b32 v2, 15, v1
v_lshrrev_b32 v3, 4, v1
v_lshrrev_b32 v4, 2, v2
v_lshl_add_u32 v4, v3, 3, v4
v_mul_u32_u24 v4, 160, v4
v_and_b32 v5, 3, v2
v_lshl_add_u32 v4, v5, 3, v4
v_add_u32 v4, 147712, v4
s_mul_i32 s34, s21, 72
v_add_u32 v5, s34, v2
v_lshlrev_b32 v5, 12, v5
v_lshl_add_u32 v5, v3, 4, v5
s_lshl_b32 s34, s22, 7
s_sub_u32 s34, 2428800, s34
v_add_u32 v5, s34, v5
v_mov_b32 v7, 0x7ff00000
s_add_u32 s34, s20, 0
s_lshr_b32 s35, s34, 1
s_and_b32 s36, s34, 1
s_mul_i32 s37, s36, 5120
s_lshl_b32 s40, s35, 5
s_add_u32 s37, s37, s40
v_add_u32 v6, s37, v4
ds_read_b64_tr_b16 v[96:97], v6
ds_read_b64_tr_b16 v[98:99], v6 offset:640
s_lshl_b32 s37, s35, 16
s_lshl_b32 s36, s36, 6
s_add_u32 s37, s37, s36
v_add_u32 v108, s37, v5
s_cmp_eq_u32 s35, 4
s_cselect_b32 s36, 8, 16
s_cmp_gt_u32 s35, 4
s_cselect_b32 s36, 0, s36
v_cmp_gt_u32 vcc, s36, v2
s_nop 1
v_cndmask_b32 v108, v7, v108, vcc
s_add_u32 s34, s20, 4
s_lshr_b32 s35, s34, 1
s_and_b32 s36, s34, 1
s_mul_i32 s37, s36, 5120
s_lshl_b32 s40, s35, 5
s_add_u32 s37, s37, s40
v_add_u32 v6, s37, v4
ds_read_b64_tr_b16 v[100:101], v6
ds_read_b64_tr_b16 v[102:103], v6 offset:640
s_lshl_b32 s37, s35, 16
s_lshl_b32 s36, s36, 6
s_add_u32 s37, s37, s36
v_add_u32 v109, s37, v5
s_cmp_eq_u32 s35, 4
s_cselect_b32 s36, 8, 16
s_cmp_gt_u32 s35, 4
s_cselect_b32 s36, 0, s36
v_cmp_gt_u32 vcc, s36, v2
s_nop 1
v_cndmask_b32 v109, v7, v109, vcc
s_add_u32 s34, s20, 8
s_lshr_b32 s35, s34, 1
s_and_b32 s36, s34, 1
s_mul_i32 s37, s36, 5120
s_lshl_b32 s40, s35, 5
s_add_u32 s37, s37, s40
v_add_u32 v6, s37, v4
ds_read_b64_tr_b16 v[104:105], v6
ds_read_b64_tr_b16 v[106:107], v6 offset:640
s_lshl_b32 s37, s35, 16
s_lshl_b32 s36, s36, 6
s_add_u32 s37, s37, s36
v_add_u32 v110, s37, v5
s_cmp_eq_u32 s35, 4
s_cselect_b32 s36, 8, 16
s_cmp_gt_u32 s35, 4
s_cselect_b32 s36, 0, s36
v_cmp_gt_u32 vcc, s36, v2
s_nop 1
v_cndmask_b32 v110, v7, v110, vcc
s_waitcnt lgkmcnt(0)
v_fma_f32 v160, v160, v120, v18
v_fma_f32 v161, v161, v120, v18
v_mul_f32 v160, v160, v32
v_mul_f32 v161, v161, v33
buffer_store_dwordx4 v[96:99], v108, s[12:15], 0 offen sc1
v_exp_f32 v160, v160
v_exp_f32 v161, v161
v_mul_f32 v162, v32, v48
v_mul_f32 v163, v33, v49
v_add_f32 v160, 1.0, v160
buffer_store_dwordx4 v[100:103], v109, s[12:15], 0 offen sc1
v_add_f32 v161, 1.0, v161
v_rcp_f32 v160, v160
v_rcp_f32 v161, v161
v_mul_f32 v162, v162, v160
v_mul_f32 v163, v163, v161
ds_write_b64 v30, v[184:185] offset:0
ds_write_b64 v30, v[186:187] offset:1024
v_cvt_pk_bf16_f32 v168, v162, v163
v_mul_f32 v164, v34, v34
v_mul_f32 v165, v35, v35
v_fma_f32 v164, v164, v120, v18
v_fma_f32 v165, v165, v120, v18
ds_write_b64 v30, v[188:189] offset:2048
ds_write_b64 v30, v[190:191] offset:3072
v_mul_f32 v164, v164, v34
v_mul_f32 v165, v165, v35
v_exp_f32 v164, v164
v_exp_f32 v165, v165
v_mul_f32 v166, v34, v50
buffer_store_dwordx4 v[104:107], v110, s[12:15], 0 offen sc1
v_mul_f32 v167, v35, v51
v_add_f32 v164, 1.0, v164
v_add_f32 v165, 1.0, v165
v_rcp_f32 v164, v164
ds_write_b64 v30, v[192:193] offset:8192
ds_write_b64 v30, v[194:195] offset:9216
v_rcp_f32 v165, v165
v_mul_f32 v166, v166, v164
v_mul_f32 v167, v167, v165
v_cvt_pk_bf16_f32 v169, v166, v167
v_mul_f32 v160, v36, v36
ds_write_b64 v30, v[196:197] offset:10240
ds_write_b64 v30, v[198:199] offset:11264
v_mul_f32 v161, v37, v37
v_fma_f32 v160, v160, v121, v21
v_fma_f32 v161, v161, v121, v21
v_mul_f32 v160, v160, v36
v_mul_f32 v161, v161, v37
v_mov_b32 v2, s56
v_mov_b32 v3, 0x7ff00000
v_cmp_eq_u32 vcc, 0, v1
v_mov_b32 v4, 0
s_nop 0
v_cndmask_b32 v2, v3, v2, vcc
buffer_store_dword v4, v2, s[12:15], 0 offen sc1
v_exp_f32 v160, v160
v_exp_f32 v161, v161
v_mul_f32 v162, v36, v52
v_mul_f32 v163, v37, v53
v_add_f32 v160, 1.0, v160
ds_write_b64 v30, v[200:201] offset:16384
ds_write_b64 v30, v[202:203] offset:17408
v_add_f32 v161, 1.0, v161
v_rcp_f32 v160, v160
v_rcp_f32 v161, v161
v_mul_f32 v162, v162, v160
v_mul_f32 v163, v163, v161
ds_write_b64 v30, v[204:205] offset:18432
ds_write_b64 v30, v[206:207] offset:19456
v_cvt_pk_bf16_f32 v170, v162, v163
v_mul_f32 v164, v38, v38
v_mul_f32 v165, v39, v39
v_fma_f32 v164, v164, v121, v21
s_lshl_b32 s36, s70, 12
s_add_u32 s36, s36, 4784128
s_cmp_lt_u32 s70, 576
s_cselect_b32 s36, s36, 0x7ff00000
v_mov_b32 v116, -1
v_mov_b32 v117, -1
v_mov_b32 v118, -1
v_mov_b32 v119, -1
buffer_store_dwordx4 v[116:119], v19, s[12:15], s36 offen sc1
v_fma_f32 v165, v165, v121, v21
v_mul_f32 v164, v164, v38
v_mul_f32 v165, v165, v39
v_exp_f32 v164, v164
v_exp_f32 v165, v165
ds_write_b64 v30, v[208:209] offset:24576
ds_write_b64 v30, v[210:211] offset:25600
v_mul_f32 v166, v38, v54
v_mul_f32 v167, v39, v55
v_add_f32 v164, 1.0, v164
v_add_f32 v165, 1.0, v165
v_rcp_f32 v164, v164
ds_write_b64 v30, v[212:213] offset:26624
ds_write_b64 v30, v[214:215] offset:27648
v_rcp_f32 v165, v165
v_mul_f32 v166, v166, v164
v_mul_f32 v167, v167, v165
v_cvt_pk_bf16_f32 v171, v166, v167
v_mul_f32 v160, v40, v40
buffer_store_dwordx4 v[116:119], v19, s[12:15], s36 offen offset:1024 sc1
v_mul_f32 v161, v41, v41
v_fma_f32 v160, v160, v122, v22
v_fma_f32 v161, v161, v122, v22
v_mul_f32 v160, v160, v40
v_mul_f32 v161, v161, v41
ds_write_b64 v31, v[216:217] offset:0
ds_write_b64 v31, v[218:219] offset:1024
v_exp_f32 v160, v160
v_exp_f32 v161, v161
v_mul_f32 v162, v40, v56
v_mul_f32 v163, v41, v57
v_add_f32 v160, 1.0, v160
ds_write_b64 v31, v[220:221] offset:2048
ds_write_b64 v31, v[222:223] offset:3072
v_add_f32 v161, 1.0, v161
v_rcp_f32 v160, v160
v_rcp_f32 v161, v161
v_mul_f32 v162, v162, v160
buffer_store_dwordx4 v[116:119], v19, s[12:15], s36 offen offset:2048 sc1
v_mul_f32 v163, v163, v161
v_cvt_pk_bf16_f32 v172, v162, v163
v_mul_f32 v164, v42, v42
v_mul_f32 v165, v43, v43
v_fma_f32 v164, v164, v122, v22
ds_write_b64 v31, v[224:225] offset:8192
ds_write_b64 v31, v[226:227] offset:9216
v_fma_f32 v165, v165, v122, v22
v_mul_f32 v164, v164, v42
v_mul_f32 v165, v165, v43
v_exp_f32 v164, v164
v_exp_f32 v165, v165
ds_write_b64 v31, v[228:229] offset:10240
ds_write_b64 v31, v[230:231] offset:11264
v_mul_f32 v166, v42, v58
v_mul_f32 v167, v43, v59
v_add_f32 v164, 1.0, v164
v_add_f32 v165, 1.0, v165
v_rcp_f32 v164, v164
buffer_store_dwordx4 v[116:119], v19, s[12:15], s36 offen offset:3072 sc1
v_rcp_f32 v165, v165
v_mul_f32 v166, v166, v164
v_mul_f32 v167, v167, v165
v_cvt_pk_bf16_f32 v173, v166, v167
v_mul_f32 v160, v44, v44
ds_write_b64 v31, v[232:233] offset:16384
ds_write_b64 v31, v[234:235] offset:17408
v_mul_f32 v161, v45, v45
v_fma_f32 v160, v160, v123, v23
v_fma_f32 v161, v161, v123, v23
v_mul_f32 v160, v160, v44
ds_write_b64 v31, v[236:237] offset:18432
ds_write_b64 v31, v[238:239] offset:19456
v_mul_f32 v161, v161, v45
v_exp_f32 v160, v160
v_exp_f32 v161, v161
v_mul_f32 v162, v44, v60
v_mul_f32 v163, v45, v61
v_lshlrev_b32 v11, 2, v1
s_cmp_ge_u32 s70, 576
s_cbranch_scc1 L_conv_skip1
s_mul_i32 s71, s20, 16640
s_add_u32 s71, s71, 73728
s_mul_i32 s78, s20, 4608
s_add_u32 s78, s78, 147712
s_lshl_b32 s76, s70, 12
s_add_u32 s88, s68, s76
s_addc_u32 s89, s69, 0
s_mov_b32 s90, 4096
s_mov_b32 s91, 0x00020000
v_add_u32 v5, 4294967280, v19
buffer_load_dwordx4 v[64:67], v5, s[88:91], 0 offen nt
v_add_u32 v6, 0, v19
buffer_load_dwordx2 v[68:69], v6, s[88:91], 0 offen nt
v_add_u32 v5, 1008, v19
buffer_load_dwordx4 v[70:73], v5, s[88:91], 0 offen nt
v_add_u32 v6, 1024, v19
buffer_load_dwordx2 v[74:75], v6, s[88:91], 0 offen nt
v_add_u32 v5, 2032, v19
buffer_load_dwordx4 v[76:79], v5, s[88:91], 0 offen nt
v_add_u32 v6, 2048, v19
buffer_load_dwordx2 v[80:81], v6, s[88:91], 0 offen nt
v_add_u32 v5, 3056, v19
buffer_load_dwordx4 v[82:85], v5, s[88:91], 0 offen nt
v_add_u32 v6, 3072, v19
buffer_load_dwordx2 v[86:87], v6, s[88:91], 0 offen nt
v_add_u32 v5, 4080, v19
buffer_load_dwordx4 v[88:91], v5, s[88:91], 0 offen nt
v_add_u32 v6, 4096, v19
buffer_load_dwordx2 v[92:93], v6, s[88:91], 0 offen nt
s_lshl_b32 s76, s70, 1
v_mov_b32 v4, s76
buffer_load_ushort v94, v4, s[96:99], 0 offen
L_conv_skip1:
v_add_f32 v160, 1.0, v160
v_add_f32 v161, 1.0, v161
v_rcp_f32 v160, v160
v_rcp_f32 v161, v161
v_mul_f32 v162, v162, v160
ds_write_b64 v31, v[240:241] offset:24576
ds_write_b64 v31, v[242:243] offset:25600
v_mul_f32 v163, v163, v161
v_cvt_pk_bf16_f32 v174, v162, v163
v_mul_f32 v164, v46, v46
v_mul_f32 v165, v47, v47
v_fma_f32 v164, v164, v123, v23
ds_write_b64 v31, v[244:245] offset:26624
ds_write_b64 v31, v[246:247] offset:27648
v_fma_f32 v165, v165, v123, v23
v_mul_f32 v164, v164, v46
v_mul_f32 v165, v165, v47
v_exp_f32 v164, v164
v_exp_f32 v165, v165
s_mul_i32 s54, s27, 23
v_min_u32 v4, 22, v1
v_add_u32 v4, s54, v4
v_min_u32 v4, 2879, v4
s_mov_b32 s55, 7456541
v_mul_hi_u32 v127, v4, s55
v_mul_u32_u24 v5, 576, v127
v_sub_u32 v5, v4, v5
v_mul_u32_u24 v5, 1152, v5
v_lshl_add_u32 v5, v127, 7, v5
s_mul_i32 s55, s21, 663552
s_add_u32 s55, s55, 512
buffer_load_dword v254, v5, s[16:19], s55 offen
v_mul_f32 v166, v46, v62
v_mul_f32 v167, v47, v63
v_add_f32 v164, 1.0, v164
v_add_f32 v165, 1.0, v165
v_rcp_f32 v164, v164
v_rcp_f32 v165, v165
v_mul_f32 v166, v166, v164
v_mul_f32 v167, v167, v165
v_cvt_pk_bf16_f32 v175, v166, v167
ds_write_b64 v31, v[168:169] offset:32768
ds_write_b64 v31, v[170:171] offset:33792
ds_write_b64 v31, v[172:173] offset:34816
ds_write_b64 v31, v[174:175] offset:35840
v_mov_b32 v2, 147456
v_mov_b32 v3, 0
ds_write_b32 v2, v3
ds_write_b32 v2, v3 offset:4
s_waitcnt lgkmcnt(0)
s_barrier
v_add_u32 v2, 65536, v20
ds_read_b128 a[0:3], v20 offset:0
ds_read_b128 a[4:7], v20 offset:1024
ds_read_b128 a[8:11], v20 offset:2048
ds_read_b128 a[12:15], v20 offset:3072
ds_read_b128 a[16:19], v20 offset:4096
ds_read_b128 a[20:23], v20 offset:5120
ds_read_b128 a[24:27], v20 offset:6144
ds_read_b128 a[28:31], v20 offset:7168
ds_read_b128 a[32:35], v20 offset:8192
ds_read_b128 a[36:39], v20 offset:9216
ds_read_b128 a[40:43], v20 offset:10240
ds_read_b128 a[44:47], v20 offset:11264
ds_read_b128 a[48:51], v20 offset:12288
ds_read_b128 a[52:55], v20 offset:13312
ds_read_b128 a[56:59], v20 offset:14336
ds_read_b128 a[60:63], v20 offset:15360
ds_read_b128 a[64:67], v20 offset:16384
ds_read_b128 a[68:71], v20 offset:17408
ds_read_b128 a[72:75], v20 offset:18432
ds_read_b128 a[76:79], v20 offset:19456
ds_read_b128 a[80:83], v20 offset:20480
ds_read_b128 a[84:87], v20 offset:21504
ds_read_b128 a[88:91], v20 offset:22528
ds_read_b128 a[92:95], v20 offset:23552
ds_read_b128 a[96:99], v20 offset:24576
ds_read_b128 a[100:103], v20 offset:25600
ds_read_b128 a[104:107], v20 offset:26624
ds_read_b128 a[108:111], v20 offset:27648
ds_read_b128 a[112:115], v20 offset:28672
ds_read_b128 a[116:119], v20 offset:29696
ds_read_b128 a[120:123], v20 offset:30720
ds_read_b128 a[124:127], v20 offset:31744
ds_read_b128 a[128:131], v20 offset:32768
ds_read_b128 a[132:135], v20 offset:33792
ds_read_b128 a[136:139], v20 offset:34816
ds_read_b128 a[140:143], v20 offset:35840
ds_read_b128 a[144:147], v20 offset:36864
ds_read_b128 a[148:151], v20 offset:37888
ds_read_b128 a[152:155], v20 offset:38912
ds_read_b128 a[156:159], v20 offset:39936
ds_read_b128 a[160:163], v20 offset:40960
ds_read_b128 a[164:167], v20 offset:41984
ds_read_b128 a[168:171], v20 offset:43008
ds_read_b128 a[172:175], v20 offset:44032
ds_read_b128 a[176:179], v20 offset:45056
ds_read_b128 a[180:183], v20 offset:46080
ds_read_b128 a[184:187], v20 offset:47104
ds_read_b128 a[188:191], v20 offset:48128
ds_read_b128 a[192:195], v20 offset:49152
ds_read_b128 a[196:199], v20 offset:50176
ds_read_b128 a[200:203], v20 offset:51200
ds_read_b128 a[204:207], v20 offset:52224
ds_read_b128 a[208:211], v20 offset:53248
ds_read_b128 a[212:215], v20 offset:54272
ds_read_b128 a[216:219], v20 offset:55296
ds_read_b128 a[220:223], v20 offset:56320
ds_read_b128 a[224:227], v20 offset:57344
ds_read_b128 a[228:231], v20 offset:58368
ds_read_b128 a[232:235], v20 offset:59392
ds_read_b128 a[236:239], v20 offset:60416
ds_read_b128 a[240:243], v20 offset:61440
ds_read_b128 a[244:247], v20 offset:62464
ds_read_b128 a[248:251], v20 offset:63488
ds_read_b128 a[252:255], v20 offset:64512
ds_read_b128 v[128:131], v2 offset:0
ds_read_b128 v[132:135], v2 offset:1024
ds_read_b128 v[136:139], v2 offset:2048
ds_read_b128 v[140:143], v2 offset:3072
ds_read_b128 v[144:147], v2 offset:4096
ds_read_b128 v[148:151], v2 offset:5120
ds_read_b128 v[152:155], v2 offset:6144
ds_read_b128 v[156:159], v2 offset:7168
s_waitcnt lgkmcnt(0)
s_barrier
s_mov_b32 s6, 5308416
s_mov_b32 s10, 5308416
s_mul_i32 s23, s21, 663552
s_add_u32 s23, s23, 128
s_mov_b32 s31, 221184
s_mov_b32 s32, 4294525056
s_add_u32 m0, s24, 73728
s_nop 0
buffer_load_dwordx4 v12, s[4:7], s23 offen lds
buffer_load_dwordx4 v13, s[4:7], s23 offen offset:1024 lds
buffer_load_dwordx4 v14, s[4:7], s23 offen offset:2048 lds
s_add_u32 m0, s25, 73728
s_nop 0
buffer_load_dwordx4 v15, s[8:11], s23 offen lds
buffer_load_dwordx4 v16, s[8:11], s23 offen offset:1024 lds
buffer_load_dwordx4 v17, s[8:11], s23 offen offset:2048 lds
s_add_u32 s23, s23, s31
s_add_u32 m0, s24, 98304
s_nop 0
buffer_load_dwordx4 v12, s[4:7], s23 offen lds
buffer_load_dwordx4 v13, s[4:7], s23 offen offset:1024 lds
buffer_load_dwordx4 v14, s[4:7], s23 offen offset:2048 lds
s_add_u32 m0, s25, 98304
s_nop 0
buffer_load_dwordx4 v15, s[8:11], s23 offen lds
buffer_load_dwordx4 v16, s[8:11], s23 offen offset:1024 lds
buffer_load_dwordx4 v17, s[8:11], s23 offen offset:2048 lds
s_mov_b32 s34, 0x7ff00000
buffer_load_dword v252, v19, s[4:7], s34 offen
buffer_load_dword v253, v19, s[4:7], s34 offen
ds_read_b64_tr_b16 v[96:97], v9 offset:0
ds_read_b64_tr_b16 v[98:99], v9 offset:2048
ds_read_b64_tr_b16 v[100:101], v9 offset:4096
ds_read_b64_tr_b16 v[102:103], v9 offset:6144
ds_read_b64_tr_b16 v[104:105], v9 offset:8192
ds_read_b64_tr_b16 v[106:107], v9 offset:10240
s_mov_b32 s30, 9
L_p2:
s_waitcnt lgkmcnt(4)
s_waitcnt vmcnt(22)
s_barrier
v_mfma_f32_16x16x32_bf16 v[32:35], v[96:99], a[0:3], 0
ds_read_b64_tr_b16 v[108:109], v9 offset:12288
ds_read_b64_tr_b16 v[110:111], v9 offset:14336
v_mfma_f32_16x16x32_bf16 v[36:39], v[96:99], a[4:7], 0
s_add_u32 s23, s23, s31
s_xor_b32 s36, s42, 73728
s_add_u32 s36, s36, 49152
s_add_u32 m0, s36, s24
v_mfma_f32_16x16x32_bf16 v[40:43], v[96:99], a[8:11], 0
buffer_load_dwordx4 v12, s[4:7], s23 offen lds
v_mfma_f32_16x16x32_bf16 v[44:47], v[96:99], a[12:15], 0
s_waitcnt lgkmcnt(4)
v_mfma_f32_16x16x32_bf16 v[32:35], v[100:103], a[16:19], v[32:35]
ds_read_b64_tr_b16 v[112:113], v9 offset:16384
ds_read_b64_tr_b16 v[114:115], v9 offset:18432
v_mfma_f32_16x16x32_bf16 v[36:39], v[100:103], a[20:23], v[36:39]
v_mfma_f32_16x16x32_bf16 v[40:43], v[100:103], a[24:27], v[40:43]
buffer_load_dwordx4 v13, s[4:7], s23 offen offset:1024 lds
v_mfma_f32_16x16x32_bf16 v[44:47], v[100:103], a[28:31], v[44:47]
s_waitcnt lgkmcnt(4)
v_mfma_f32_16x16x32_bf16 v[32:35], v[104:107], a[32:35], v[32:35]
ds_read_b64_tr_b16 v[116:117], v9 offset:20480
ds_read_b64_tr_b16 v[118:119], v9 offset:22528
v_mfma_f32_16x16x32_bf16 v[36:39], v[104:107], a[36:39], v[36:39]
v_mfma_f32_16x16x32_bf16 v[40:43], v[104:107], a[40:43], v[40:43]
buffer_load_dwordx4 v14, s[4:7], s23 offen offset:2048 lds
v_mfma_f32_16x16x32_bf16 v[44:47], v[104:107], a[44:47], v[44:47]
s_waitcnt lgkmcnt(4)
v_mfma_f32_16x16x32_bf16 v[32:35], v[108:111], a[48:51], v[32:35]
ds_read_b64_tr_b16 v[96:97], v9 offset:24576
ds_read_b64_tr_b16 v[98:99], v9 offset:26624
v_mfma_f32_16x16x32_bf16 v[36:39], v[108:111], a[52:55], v[36:39]
s_add_u32 m0, s36, s25
v_mfma_f32_16x16x32_bf16 v[40:43], v[108:111], a[56:59], v[40:43]
buffer_load_dwordx4 v15, s[8:11], s23 offen lds
v_mfma_f32_16x16x32_bf16 v[44:47], v[108:111], a[60:63], v[44:47]
s_waitcnt lgkmcnt(4)
v_mfma_f32_16x16x32_bf16 v[32:35], v[112:115], a[64:67], v[32:35]
ds_read_b64_tr_b16 v[100:101], v9 offset:28672
ds_read_b64_tr_b16 v[102:103], v9 offset:30720
v_mfma_f32_16x16x32_bf16 v[36:39], v[112:115], a[68:71], v[36:39]
v_mfma_f32_16x16x32_bf16 v[40:43], v[112:115], a[72:75], v[40:43]
buffer_load_dwordx4 v16, s[8:11], s23 offen offset:1024 lds
v_mfma_f32_16x16x32_bf16 v[44:47], v[112:115], a[76:79], v[44:47]
s_waitcnt lgkmcnt(4)
v_mfma_f32_16x16x32_bf16 v[32:35], v[116:119], a[80:83], v[32:35]
ds_read_b64_tr_b16 v[104:105], v9 offset:32768
ds_read_b64_tr_b16 v[106:107], v9 offset:34816
v_mfma_f32_16x16x32_bf16 v[36:39], v[116:119], a[84:87], v[36:39]
v_mfma_f32_16x16x32_bf16 v[40:43], v[116:119], a[88:91], v[40:43]
buffer_load_dwordx4 v17, s[8:11], s23 offen offset:2048 lds
v_mfma_f32_16x16x32_bf16 v[44:47], v[116:119], a[92:95], v[44:47]
s_waitcnt lgkmcnt(4)
s_waitcnt vmcnt(20)
s_barrier
v_mfma_f32_16x16x32_bf16 v[32:35], v[96:99], a[96:99], v[32:35]
ds_read_b64_tr_b16 v[108:109], v9 offset:36864
ds_read_b64_tr_b16 v[110:111], v9 offset:38912
v_mfma_f32_16x16x32_bf16 v[36:39], v[96:99], a[100:103], v[36:39]
s_add_u32 s23, s23, s32
s_add_u32 s36, s42, 0
s_add_u32 m0, s36, s24
v_mfma_f32_16x16x32_bf16 v[40:43], v[96:99], a[104:107], v[40:43]
buffer_load_dwordx4 v12, s[4:7], s23 offen lds
v_mfma_f32_16x16x32_bf16 v[44:47], v[96:99], a[108:111], v[44:47]
s_waitcnt lgkmcnt(4)
v_mfma_f32_16x16x32_bf16 v[32:35], v[100:103], a[112:115], v[32:35]
ds_read_b64_tr_b16 v[112:113], v9 offset:40960
ds_read_b64_tr_b16 v[114:115], v9 offset:43008
v_mfma_f32_16x16x32_bf16 v[36:39], v[100:103], a[116:119], v[36:39]
v_mfma_f32_16x16x32_bf16 v[40:43], v[100:103], a[120:123], v[40:43]
buffer_load_dwordx4 v13, s[4:7], s23 offen offset:1024 lds
v_mfma_f32_16x16x32_bf16 v[44:47], v[100:103], a[124:127], v[44:47]
s_waitcnt lgkmcnt(4)
v_mfma_f32_16x16x32_bf16 v[32:35], v[104:107], a[128:131], v[32:35]
ds_read_b64_tr_b16 v[116:117], v9 offset:45056
ds_read_b64_tr_b16 v[118:119], v9 offset:47104
v_mfma_f32_16x16x32_bf16 v[36:39], v[104:107], a[132:135], v[36:39]
v_mfma_f32_16x16x32_bf16 v[40:43], v[104:107], a[136:139], v[40:43]
buffer_load_dwordx4 v14, s[4:7], s23 offen offset:2048 lds
v_mfma_f32_16x16x32_bf16 v[44:47], v[104:107], a[140:143], v[44:47]
s_and_b32 s34, s22, 3
s_sub_u32 s34, 8, s34
s_cmp_lg_u32 s30, s34
s_cbranch_scc1 L_nokvadd
s_cmp_lg_u32 s20, 0
s_cbranch_scc1 L_nokvadd
v_mov_b32 v2, s2
v_mov_b32 v3, 1
v_cmp_eq_u32 vcc, 0, v1
s_and_saveexec_b64 s[40:41], vcc
buffer_store_byte v3, v2, s[44:47], 0 offen sc1
s_mov_b64 exec, s[40:41]
L_nokvadd:
s_waitcnt lgkmcnt(4)
v_mfma_f32_16x16x32_bf16 v[32:35], v[108:111], a[144:147], v[32:35]
ds_read_b64_tr_b16 v[96:97], v9 offset:49152
ds_read_b64_tr_b16 v[98:99], v9 offset:51200
v_mfma_f32_16x16x32_bf16 v[36:39], v[108:111], a[148:151], v[36:39]
s_add_u32 m0, s36, s25
v_mfma_f32_16x16x32_bf16 v[40:43], v[108:111], a[152:155], v[40:43]
buffer_load_dwordx4 v15, s[8:11], s23 offen lds
v_mfma_f32_16x16x32_bf16 v[44:47], v[108:111], a[156:159], v[44:47]
s_waitcnt lgkmcnt(4)
v_mfma_f32_16x16x32_bf16 v[32:35], v[112:115], a[160:163], v[32:35]
ds_read_b64_tr_b16 v[100:101], v9 offset:53248
ds_read_b64_tr_b16 v[102:103], v9 offset:55296
v_mfma_f32_16x16x32_bf16 v[36:39], v[112:115], a[164:167], v[36:39]
v_mfma_f32_16x16x32_bf16 v[40:43], v[112:115], a[168:171], v[40:43]
buffer_load_dwordx4 v16, s[8:11], s23 offen offset:1024 lds
v_mfma_f32_16x16x32_bf16 v[44:47], v[112:115], a[172:175], v[44:47]
s_waitcnt lgkmcnt(4)
v_mfma_f32_16x16x32_bf16 v[32:35], v[116:119], a[176:179], v[32:35]
ds_read_b64_tr_b16 v[104:105], v9 offset:57344
ds_read_b64_tr_b16 v[106:107], v9 offset:59392
v_mfma_f32_16x16x32_bf16 v[36:39], v[116:119], a[180:183], v[36:39]
v_mfma_f32_16x16x32_bf16 v[40:43], v[116:119], a[184:187], v[40:43]
buffer_load_dwordx4 v17, s[8:11], s23 offen offset:2048 lds
v_mfma_f32_16x16x32_bf16 v[44:47], v[116:119], a[188:191], v[44:47]
s_waitcnt lgkmcnt(4)
s_waitcnt vmcnt(20)
s_barrier
v_mfma_f32_16x16x32_bf16 v[32:35], v[96:99], a[192:195], v[32:35]
ds_read_b64_tr_b16 v[108:109], v9 offset:61440
ds_read_b64_tr_b16 v[110:111], v9 offset:63488
v_mfma_f32_16x16x32_bf16 v[36:39], v[96:99], a[196:199], v[36:39]
s_add_u32 s23, s23, s31
s_add_u32 s36, s42, 24576
s_add_u32 m0, s36, s24
v_mfma_f32_16x16x32_bf16 v[40:43], v[96:99], a[200:203], v[40:43]
buffer_load_dwordx4 v12, s[4:7], s23 offen lds
v_mfma_f32_16x16x32_bf16 v[44:47], v[96:99], a[204:207], v[44:47]
s_waitcnt lgkmcnt(4)
v_mfma_f32_16x16x32_bf16 v[32:35], v[100:103], a[208:211], v[32:35]
ds_read_b64_tr_b16 v[112:113], v10 offset:32768
ds_read_b64_tr_b16 v[114:115], v10 offset:34816
v_mfma_f32_16x16x32_bf16 v[36:39], v[100:103], a[212:215], v[36:39]
v_mfma_f32_16x16x32_bf16 v[40:43], v[100:103], a[216:219], v[40:43]
buffer_load_dwordx4 v13, s[4:7], s23 offen offset:1024 lds
v_mfma_f32_16x16x32_bf16 v[44:47], v[100:103], a[220:223], v[44:47]
s_waitcnt lgkmcnt(4)
v_mfma_f32_16x16x32_bf16 v[32:35], v[104:107], a[224:227], v[32:35]
ds_read_b64_tr_b16 v[116:117], v10 offset:36864
ds_read_b64_tr_b16 v[118:119], v10 offset:38912
v_mfma_f32_16x16x32_bf16 v[36:39], v[104:107], a[228:231], v[36:39]
v_mfma_f32_16x16x32_bf16 v[40:43], v[104:107], a[232:235], v[40:43]
buffer_load_dwordx4 v14, s[4:7], s23 offen offset:2048 lds
v_mfma_f32_16x16x32_bf16 v[44:47], v[104:107], a[236:239], v[44:47]
s_waitcnt lgkmcnt(4)
v_mfma_f32_16x16x32_bf16 v[32:35], v[108:111], a[240:243], v[32:35]
v_xor_b32 v9, 73728, v9
v_xor_b32 v10, 73728, v10
ds_read_b64_tr_b16 v[96:97], v9 offset:0
ds_read_b64_tr_b16 v[98:99], v9 offset:2048
v_mfma_f32_16x16x32_bf16 v[36:39], v[108:111], a[244:247], v[36:39]
s_add_u32 m0, s36, s25
v_mfma_f32_16x16x32_bf16 v[40:43], v[108:111], a[248:251], v[40:43]
buffer_load_dwordx4 v15, s[8:11], s23 offen lds
v_mfma_f32_16x16x32_bf16 v[44:47], v[108:111], a[252:255], v[44:47]
s_waitcnt lgkmcnt(4)
v_mfma_f32_16x16x32_bf16 v[32:35], v[112:115], v[128:131], v[32:35]
ds_read_b64_tr_b16 v[100:101], v9 offset:4096
ds_read_b64_tr_b16 v[102:103], v9 offset:6144
v_mfma_f32_16x16x32_bf16 v[36:39], v[112:115], v[132:135], v[36:39]
v_mfma_f32_16x16x32_bf16 v[40:43], v[112:115], v[136:139], v[40:43]
buffer_load_dwordx4 v16, s[8:11], s23 offen offset:1024 lds
v_mfma_f32_16x16x32_bf16 v[44:47], v[112:115], v[140:143], v[44:47]
s_waitcnt lgkmcnt(4)
v_mfma_f32_16x16x32_bf16 v[32:35], v[116:119], v[144:147], v[32:35]
ds_read_b64_tr_b16 v[104:105], v9 offset:8192
ds_read_b64_tr_b16 v[106:107], v9 offset:10240
v_mfma_f32_16x16x32_bf16 v[36:39], v[116:119], v[148:151], v[36:39]
v_mfma_f32_16x16x32_bf16 v[40:43], v[116:119], v[152:155], v[40:43]
buffer_load_dwordx4 v17, s[8:11], s23 offen offset:2048 lds
v_mfma_f32_16x16x32_bf16 v[44:47], v[116:119], v[156:159], v[44:47]
s_xor_b32 s42, s42, 73728
s_sub_u32 s30, s30, 1
s_nop 4
v_cvt_pk_bf16_f32 v160, v32, v33
v_cvt_pk_bf16_f32 v161, v34, v35
v_cvt_pk_bf16_f32 v162, v36, v37
v_cvt_pk_bf16_f32 v163, v38, v39
v_cvt_pk_bf16_f32 v164, v40, v41
v_cvt_pk_bf16_f32 v165, v42, v43
v_cvt_pk_bf16_f32 v166, v44, v45
v_cvt_pk_bf16_f32 v167, v46, v47
buffer_store_dwordx4 v[160:163], v19, s[12:15], s38 offen sc1
buffer_store_dwordx4 v[164:167], v19, s[12:15], s38 offen offset:1024 sc1
s_add_u32 s38, s38, 8192
s_cmp_gt_u32 s30, 2
s_cbranch_scc1 L_p2
L_p2b:
s_waitcnt lgkmcnt(4)
s_cmp_eq_u32 s30, 2
s_cbranch_scc1 L_p2wa0
s_waitcnt vmcnt(10)
s_cmp_lg_u32 s20, 0
s_cbranch_scc1 L_p2wj0
s_waitcnt vmcnt(2)
v_cmp_eq_u32 vcc, 0x01010101, v95
s_nop 0
s_cmp_eq_u64 vcc, exec
s_cbranch_scc1 L_p2wj0
s_mov_b32 s77, 0
L_poll_kv:
buffer_load_dword v3, v11, s[44:47], 0 offen sc1
s_waitcnt vmcnt(0)
v_cmp_eq_u32 vcc, 0x01010101, v3
s_add_u32 s77, s77, 1
s_cmp_eq_u64 vcc, exec
s_cbranch_scc1 L_pollok_kv
s_cmp_lt_u32 s77, 20000
s_cbranch_scc0 L_pollok_kv
s_sleep 8
s_branch L_poll_kv
L_pollok_kv:
s_branch L_p2wj0
L_p2wa0:
s_waitcnt vmcnt(22)
L_p2wj0:
s_barrier
v_mfma_f32_16x16x32_bf16 v[32:35], v[96:99], a[0:3], 0
ds_read_b64_tr_b16 v[108:109], v9 offset:12288
ds_read_b64_tr_b16 v[110:111], v9 offset:14336
v_mfma_f32_16x16x32_bf16 v[36:39], v[96:99], a[4:7], 0
v_mfma_f32_16x16x32_bf16 v[40:43], v[96:99], a[8:11], 0
v_mfma_f32_16x16x32_bf16 v[44:47], v[96:99], a[12:15], 0
s_cmp_lg_u32 s30, 2
s_cbranch_scc1 L_p2nog
s_add_u32 s23, s23, s31
s_xor_b32 s36, s42, 73728
s_add_u32 s36, s36, 49152
s_add_u32 m0, s36, s24
s_nop 0
buffer_load_dwordx4 v12, s[4:7], s23 offen lds
buffer_load_dwordx4 v13, s[4:7], s23 offen offset:1024 lds
buffer_load_dwordx4 v14, s[4:7], s23 offen offset:2048 lds
s_add_u32 m0, s36, s25
s_nop 0
buffer_load_dwordx4 v15, s[8:11], s23 offen lds
buffer_load_dwordx4 v16, s[8:11], s23 offen offset:1024 lds
buffer_load_dwordx4 v17, s[8:11], s23 offen offset:2048 lds
s_cmp_lg_u32 s20, 0
s_cbranch_scc1 L_p2noxr
buffer_load_dword v95, v11, s[44:47], 0 offen sc1
s_branch L_p2noxr
L_p2nog:
s_cmp_ge_u32 s70, 576
s_cbranch_scc1 L_conv_skip2
s_lshl_b32 s76, s70, 12
s_add_u32 s76, s76, 2424832
s_mov_b32 m0, s78
s_nop 0
buffer_load_dwordx4 v19, s[12:15], s76 offen sc1 lds
buffer_load_dwordx4 v19, s[12:15], s76 offen offset:1024 sc1 lds
buffer_load_dwordx4 v19, s[12:15], s76 offen offset:2048 sc1 lds
buffer_load_dwordx4 v19, s[12:15], s76 offen offset:3072 sc1 lds
L_conv_skip2:
L_p2noxr:
s_waitcnt lgkmcnt(4)
v_mfma_f32_16x16x32_bf16 v[32:35], v[100:103], a[16:19], v[32:35]
ds_read_b64_tr_b16 v[112:113], v9 offset:16384
ds_read_b64_tr_b16 v[114:115], v9 offset:18432
v_mfma_f32_16x16x32_bf16 v[36:39], v[100:103], a[20:23], v[36:39]
v_mfma_f32_16x16x32_bf16 v[40:43], v[100:103], a[24:27], v[40:43]
v_mfma_f32_16x16x32_bf16 v[44:47], v[100:103], a[28:31], v[44:47]
s_waitcnt lgkmcnt(4)
v_mfma_f32_16x16x32_bf16 v[32:35], v[104:107], a[32:35], v[32:35]
ds_read_b64_tr_b16 v[116:117], v9 offset:20480
ds_read_b64_tr_b16 v[118:119], v9 offset:22528
v_mfma_f32_16x16x32_bf16 v[36:39], v[104:107], a[36:39], v[36:39]
v_mfma_f32_16x16x32_bf16 v[40:43], v[104:107], a[40:43], v[40:43]
v_mfma_f32_16x16x32_bf16 v[44:47], v[104:107], a[44:47], v[44:47]
s_waitcnt lgkmcnt(4)
v_mfma_f32_16x16x32_bf16 v[32:35], v[108:111], a[48:51], v[32:35]
ds_read_b64_tr_b16 v[96:97], v9 offset:24576
ds_read_b64_tr_b16 v[98:99], v9 offset:26624
v_mfma_f32_16x16x32_bf16 v[36:39], v[108:111], a[52:55], v[36:39]
v_mfma_f32_16x16x32_bf16 v[40:43], v[108:111], a[56:59], v[40:43]
v_mfma_f32_16x16x32_bf16 v[44:47], v[108:111], a[60:63], v[44:47]
s_waitcnt lgkmcnt(4)
v_mfma_f32_16x16x32_bf16 v[32:35], v[112:115], a[64:67], v[32:35]
ds_read_b64_tr_b16 v[100:101], v9 offset:28672
ds_read_b64_tr_b16 v[102:103], v9 offset:30720
v_mfma_f32_16x16x32_bf16 v[36:39], v[112:115], a[68:71], v[36:39]
v_mfma_f32_16x16x32_bf16 v[40:43], v[112:115], a[72:75], v[40:43]
v_mfma_f32_16x16x32_bf16 v[44:47], v[112:115], a[76:79], v[44:47]
s_waitcnt lgkmcnt(4)
v_mfma_f32_16x16x32_bf16 v[32:35], v[116:119], a[80:83], v[32:35]
ds_read_b64_tr_b16 v[104:105], v9 offset:32768
ds_read_b64_tr_b16 v[106:107], v9 offset:34816
v_mfma_f32_16x16x32_bf16 v[36:39], v[116:119], a[84:87], v[36:39]
v_mfma_f32_16x16x32_bf16 v[40:43], v[116:119], a[88:91], v[40:43]
v_mfma_f32_16x16x32_bf16 v[44:47], v[116:119], a[92:95], v[44:47]
s_waitcnt lgkmcnt(4)
s_cmp_eq_u32 s30, 2
s_cbranch_scc1 L_p2wa1
s_waitcnt vmcnt(2)
s_branch L_p2wj1
L_p2wa1:
s_waitcnt vmcnt(20)
L_p2wj1:
s_barrier
v_mfma_f32_16x16x32_bf16 v[32:35], v[96:99], a[96:99], v[32:35]
ds_read_b64_tr_b16 v[108:109], v9 offset:36864
ds_read_b64_tr_b16 v[110:111], v9 offset:38912
v_mfma_f32_16x16x32_bf16 v[36:39], v[96:99], a[100:103], v[36:39]
v_mfma_f32_16x16x32_bf16 v[40:43], v[96:99], a[104:107], v[40:43]
v_mfma_f32_16x16x32_bf16 v[44:47], v[96:99], a[108:111], v[44:47]
s_cmp_lg_u32 s30, 1
s_cbranch_scc1 L_nopub1
v_mov_b32 v4, 0
v_mov_b32 v5, 1
v_cmp_eq_u32 vcc, 0, v1
s_and_saveexec_b64 s[40:41], vcc
buffer_store_dword v5, v4, s[12:15], s56 offen sc1
s_mov_b64 exec, s[40:41]
L_nopub1:
s_waitcnt lgkmcnt(4)
v_mfma_f32_16x16x32_bf16 v[32:35], v[100:103], a[112:115], v[32:35]
ds_read_b64_tr_b16 v[112:113], v9 offset:40960
ds_read_b64_tr_b16 v[114:115], v9 offset:43008
v_mfma_f32_16x16x32_bf16 v[36:39], v[100:103], a[116:119], v[36:39]
v_mfma_f32_16x16x32_bf16 v[40:43], v[100:103], a[120:123], v[40:43]
v_mfma_f32_16x16x32_bf16 v[44:47], v[100:103], a[124:127], v[44:47]
s_waitcnt lgkmcnt(4)
v_mfma_f32_16x16x32_bf16 v[32:35], v[104:107], a[128:131], v[32:35]
ds_read_b64_tr_b16 v[116:117], v9 offset:45056
ds_read_b64_tr_b16 v[118:119], v9 offset:47104
v_mfma_f32_16x16x32_bf16 v[36:39], v[104:107], a[132:135], v[36:39]
v_mfma_f32_16x16x32_bf16 v[40:43], v[104:107], a[136:139], v[40:43]
v_mfma_f32_16x16x32_bf16 v[44:47], v[104:107], a[140:143], v[44:47]
s_waitcnt lgkmcnt(4)
v_mfma_f32_16x16x32_bf16 v[32:35], v[108:111], a[144:147], v[32:35]
ds_read_b64_tr_b16 v[96:97], v9 offset:49152
ds_read_b64_tr_b16 v[98:99], v9 offset:51200
v_mfma_f32_16x16x32_bf16 v[36:39], v[108:111], a[148:151], v[36:39]
v_mfma_f32_16x16x32_bf16 v[40:43], v[108:111], a[152:155], v[40:43]
v_mfma_f32_16x16x32_bf16 v[44:47], v[108:111], a[156:159], v[44:47]
s_waitcnt lgkmcnt(4)
v_mfma_f32_16x16x32_bf16 v[32:35], v[112:115], a[160:163], v[32:35]
ds_read_b64_tr_b16 v[100:101], v9 offset:53248
ds_read_b64_tr_b16 v[102:103], v9 offset:55296
v_mfma_f32_16x16x32_bf16 v[36:39], v[112:115], a[164:167], v[36:39]
v_mfma_f32_16x16x32_bf16 v[40:43], v[112:115], a[168:171], v[40:43]
v_mfma_f32_16x16x32_bf16 v[44:47], v[112:115], a[172:175], v[44:47]
s_waitcnt lgkmcnt(4)
v_mfma_f32_16x16x32_bf16 v[32:35], v[116:119], a[176:179], v[32:35]
ds_read_b64_tr_b16 v[104:105], v9 offset:57344
ds_read_b64_tr_b16 v[106:107], v9 offset:59392
v_mfma_f32_16x16x32_bf16 v[36:39], v[116:119], a[180:183], v[36:39]
v_mfma_f32_16x16x32_bf16 v[40:43], v[116:119], a[184:187], v[40:43]
v_mfma_f32_16x16x32_bf16 v[44:47], v[116:119], a[188:191], v[44:47]
s_waitcnt lgkmcnt(4)
s_cmp_eq_u32 s30, 2
s_cbranch_scc1 L_p2wa2
s_waitcnt vmcnt(2)
s_branch L_p2wj2
L_p2wa2:
s_waitcnt vmcnt(14)
L_p2wj2:
s_barrier
v_mfma_f32_16x16x32_bf16 v[32:35], v[96:99], a[192:195], v[32:35]
ds_read_b64_tr_b16 v[108:109], v9 offset:61440
ds_read_b64_tr_b16 v[110:111], v9 offset:63488
v_mfma_f32_16x16x32_bf16 v[36:39], v[96:99], a[196:199], v[36:39]
v_mfma_f32_16x16x32_bf16 v[40:43], v[96:99], a[200:203], v[40:43]
v_mfma_f32_16x16x32_bf16 v[44:47], v[96:99], a[204:207], v[44:47]
s_waitcnt lgkmcnt(4)
v_mfma_f32_16x16x32_bf16 v[32:35], v[100:103], a[208:211], v[32:35]
ds_read_b64_tr_b16 v[112:113], v10 offset:32768
ds_read_b64_tr_b16 v[114:115], v10 offset:34816
v_mfma_f32_16x16x32_bf16 v[36:39], v[100:103], a[212:215], v[36:39]
v_mfma_f32_16x16x32_bf16 v[40:43], v[100:103], a[216:219], v[40:43]
v_mfma_f32_16x16x32_bf16 v[44:47], v[100:103], a[220:223], v[44:47]
s_waitcnt lgkmcnt(4)
v_mfma_f32_16x16x32_bf16 v[32:35], v[104:107], a[224:227], v[32:35]
ds_read_b64_tr_b16 v[116:117], v10 offset:36864
ds_read_b64_tr_b16 v[118:119], v10 offset:38912
v_mfma_f32_16x16x32_bf16 v[36:39], v[104:107], a[228:231], v[36:39]
v_mfma_f32_16x16x32_bf16 v[40:43], v[104:107], a[232:235], v[40:43]
v_mfma_f32_16x16x32_bf16 v[44:47], v[104:107], a[236:239], v[44:47]
s_waitcnt lgkmcnt(4)
v_mfma_f32_16x16x32_bf16 v[32:35], v[108:111], a[240:243], v[32:35]
v_xor_b32 v9, 73728, v9
v_xor_b32 v10, 73728, v10
ds_read_b64_tr_b16 v[96:97], v9 offset:0
ds_read_b64_tr_b16 v[98:99], v9 offset:2048
v_mfma_f32_16x16x32_bf16 v[36:39], v[108:111], a[244:247], v[36:39]
v_mfma_f32_16x16x32_bf16 v[40:43], v[108:111], a[248:251], v[40:43]
v_mfma_f32_16x16x32_bf16 v[44:47], v[108:111], a[252:255], v[44:47]
s_waitcnt lgkmcnt(4)
v_mfma_f32_16x16x32_bf16 v[32:35], v[112:115], v[128:131], v[32:35]
ds_read_b64_tr_b16 v[100:101], v9 offset:4096
ds_read_b64_tr_b16 v[102:103], v9 offset:6144
v_mfma_f32_16x16x32_bf16 v[36:39], v[112:115], v[132:135], v[36:39]
v_mfma_f32_16x16x32_bf16 v[40:43], v[112:115], v[136:139], v[40:43]
v_mfma_f32_16x16x32_bf16 v[44:47], v[112:115], v[140:143], v[44:47]
s_waitcnt lgkmcnt(4)
v_mfma_f32_16x16x32_bf16 v[32:35], v[116:119], v[144:147], v[32:35]
ds_read_b64_tr_b16 v[104:105], v9 offset:8192
ds_read_b64_tr_b16 v[106:107], v9 offset:10240
v_mfma_f32_16x16x32_bf16 v[36:39], v[116:119], v[148:151], v[36:39]
v_mfma_f32_16x16x32_bf16 v[40:43], v[116:119], v[152:155], v[40:43]
v_mfma_f32_16x16x32_bf16 v[44:47], v[116:119], v[156:159], v[44:47]
s_xor_b32 s42, s42, 73728
s_sub_u32 s30, s30, 1
s_nop 4
v_cvt_pk_bf16_f32 v160, v32, v33
v_cvt_pk_bf16_f32 v161, v34, v35
v_cvt_pk_bf16_f32 v162, v36, v37
v_cvt_pk_bf16_f32 v163, v38, v39
v_cvt_pk_bf16_f32 v164, v40, v41
v_cvt_pk_bf16_f32 v165, v42, v43
v_cvt_pk_bf16_f32 v166, v44, v45
v_cvt_pk_bf16_f32 v167, v46, v47
buffer_store_dwordx4 v[160:163], v19, s[12:15], s38 offen sc1
buffer_store_dwordx4 v[164:167], v19, s[12:15], s38 offen offset:1024 sc1
s_add_u32 s38, s38, 8192
s_cmp_gt_u32 s30, 0
s_cbranch_scc1 L_p2b
s_waitcnt lgkmcnt(0)
s_barrier
s_mov_b32 s57, s21
s_mov_b32 s55, s20
s_cmp_ge_u32 s70, 576
s_cbranch_scc1 L_noconv
v_mov_b32 v32, 0
v_mov_b32 v33, 0
v_mov_b32 v34, 0
v_mov_b32 v35, 0
v_add_u32 v5, s78, v19
v_cmp_gt_u32 vcc, 32, v1
s_and_saveexec_b64 s[40:41], vcc
ds_write_b128 v5, v[32:35] offset:4096
s_mov_b64 exec, s[40:41]
v_mul_u32_u24 v6, 4160, v1
v_add_u32 v6, s71, v6
v_cmp_gt_u32 vcc, 4, v1
s_and_saveexec_b64 s[40:41], vcc
ds_write_b128 v6, v[32:35]
s_mov_b64 exec, s[40:41]
v_add_u32 v7, s71, v19
v_mov_b32 v96, v64
v_alignbit_b32 v100, v65, v64, 16
v_mov_b32 v104, v65
v_alignbit_b32 v108, v66, v65, 16
v_mov_b32 v97, v65
v_alignbit_b32 v101, v66, v65, 16
v_mov_b32 v105, v66
v_alignbit_b32 v109, v67, v66, 16
v_mov_b32 v98, v66
v_alignbit_b32 v102, v67, v66, 16
v_mov_b32 v106, v67
v_alignbit_b32 v110, v68, v67, 16
v_mov_b32 v99, v67
v_alignbit_b32 v103, v68, v67, 16
v_mov_b32 v107, v68
v_alignbit_b32 v111, v69, v68, 16
ds_write_b128 v7, v[96:99] offset:16
ds_write_b128 v7, v[100:103] offset:4176
ds_write_b128 v7, v[104:107] offset:8336
ds_write_b128 v7, v[108:111] offset:12496
v_mov_b32 v112, v70
v_alignbit_b32 v116, v71, v70, 16
v_mov_b32 v120, v71
v_alignbit_b32 v124, v72, v71, 16
v_mov_b32 v113, v71
v_alignbit_b32 v117, v72, v71, 16
v_mov_b32 v121, v72
v_alignbit_b32 v125, v73, v72, 16
v_mov_b32 v114, v72
v_alignbit_b32 v118, v73, v72, 16
v_mov_b32 v122, v73
v_alignbit_b32 v126, v74, v73, 16
v_mov_b32 v115, v73
v_alignbit_b32 v119, v74, v73, 16
v_mov_b32 v123, v74
v_alignbit_b32 v127, v75, v74, 16
ds_write_b128 v7, v[112:115] offset:1040
ds_write_b128 v7, v[116:119] offset:5200
ds_write_b128 v7, v[120:123] offset:9360
ds_write_b128 v7, v[124:127] offset:13520
v_mov_b32 v96, v76
v_alignbit_b32 v100, v77, v76, 16
v_mov_b32 v104, v77
v_alignbit_b32 v108, v78, v77, 16
v_mov_b32 v97, v77
v_alignbit_b32 v101, v78, v77, 16
v_mov_b32 v105, v78
v_alignbit_b32 v109, v79, v78, 16
v_mov_b32 v98, v78
v_alignbit_b32 v102, v79, v78, 16
v_mov_b32 v106, v79
v_alignbit_b32 v110, v80, v79, 16
v_mov_b32 v99, v79
v_alignbit_b32 v103, v80, v79, 16
v_mov_b32 v107, v80
v_alignbit_b32 v111, v81, v80, 16
ds_write_b128 v7, v[96:99] offset:2064
ds_write_b128 v7, v[100:103] offset:6224
ds_write_b128 v7, v[104:107] offset:10384
ds_write_b128 v7, v[108:111] offset:14544
v_mov_b32 v112, v82
v_alignbit_b32 v116, v83, v82, 16
v_mov_b32 v120, v83
v_alignbit_b32 v124, v84, v83, 16
v_mov_b32 v113, v83
v_alignbit_b32 v117, v84, v83, 16
v_mov_b32 v121, v84
v_alignbit_b32 v125, v85, v84, 16
v_mov_b32 v114, v84
v_alignbit_b32 v118, v85, v84, 16
v_mov_b32 v122, v85
v_alignbit_b32 v126, v86, v85, 16
v_mov_b32 v115, v85
v_alignbit_b32 v119, v86, v85, 16
v_mov_b32 v123, v86
v_alignbit_b32 v127, v87, v86, 16
ds_write_b128 v7, v[112:115] offset:3088
ds_write_b128 v7, v[116:119] offset:7248
ds_write_b128 v7, v[120:123] offset:11408
ds_write_b128 v7, v[124:127] offset:15568
v_cmp_eq_u32 vcc, 0, v1
s_and_saveexec_b64 s[40:41], vcc
v_mov_b32 v96, v88
v_alignbit_b32 v100, v89, v88, 16
v_mov_b32 v104, v89
v_alignbit_b32 v108, v90, v89, 16
v_mov_b32 v97, v89
v_alignbit_b32 v101, v90, v89, 16
v_mov_b32 v105, v90
v_alignbit_b32 v109, v91, v90, 16
v_mov_b32 v98, v90
v_alignbit_b32 v102, v91, v90, 16
v_mov_b32 v106, v91
v_alignbit_b32 v110, v92, v91, 16
v_mov_b32 v99, v91
v_alignbit_b32 v103, v92, v91, 16
v_mov_b32 v107, v92
v_alignbit_b32 v111, v93, v92, 16
ds_write_b128 v7, v[96:99] offset:4112
ds_write_b128 v7, v[100:103] offset:8272
ds_write_b128 v7, v[104:107] offset:12432
ds_write_b128 v7, v[108:111] offset:16592
s_mov_b64 exec, s[40:41]
v_and_b32 v14, 15, v1
v_lshrrev_b32 v15, 4, v1
v_lshlrev_b32 v16, 5, v14
v_lshlrev_b32 v17, 4, v15
v_sub_u32 v16, v17, v16
s_add_u32 s76, s78, 480
v_add_u32 v16, s76, v16
v_add_u32 v2, 1, v14
v_and_b32 v3, 3, v2
v_mul_u32_u24 v3, 4160, v3
v_lshrrev_b32 v2, 2, v2
v_lshl_add_u32 v3, v2, 3, v3
v_lshl_add_u32 v3, v15, 4, v3
v_add_u32 v13, s71, v3
s_waitcnt lgkmcnt(0) vmcnt(2)
ds_read_b64 v[96:97], v13 offset:0
ds_read_b64 v[98:99], v13 offset:8
ds_read_b128 a[28:31], v16 offset:3584
ds_read_b128 a[60:63], v16 offset:3072
ds_read_b128 a[92:95], v16 offset:2560
ds_read_b128 a[124:127], v16 offset:2048
ds_read_b128 a[156:159], v16 offset:1536
ds_read_b128 a[188:191], v16 offset:1024
ds_read_b128 a[220:223], v16 offset:512
ds_read_b128 a[252:255], v16 offset:0
ds_read_b64 v[100:101], v13 offset:64
ds_read_b64 v[102:103], v13 offset:72
s_waitcnt lgkmcnt(10)
s_waitcnt lgkmcnt(9)
v_mfma_f32_16x16x32_bf16 v[32:35], v[96:99], a[28:31], 0
ds_read_b128 a[24:27], v16 offset:3648
s_waitcnt lgkmcnt(9)
v_mfma_f32_16x16x32_bf16 v[36:39], v[96:99], a[60:63], 0
ds_read_b128 a[56:59], v16 offset:3136
s_waitcnt lgkmcnt(9)
v_mfma_f32_16x16x32_bf16 v[40:43], v[96:99], a[92:95], 0
ds_read_b128 a[88:91], v16 offset:2624
s_waitcnt lgkmcnt(9)
v_mfma_f32_16x16x32_bf16 v[44:47], v[96:99], a[124:127], 0
ds_read_b128 a[120:123], v16 offset:2112
s_waitcnt lgkmcnt(9)
v_mfma_f32_16x16x32_bf16 v[48:51], v[96:99], a[156:159], 0
ds_read_b128 a[152:155], v16 offset:1600
s_waitcnt lgkmcnt(9)
v_mfma_f32_16x16x32_bf16 v[52:55], v[96:99], a[188:191], 0
ds_read_b128 a[184:187], v16 offset:1088
s_waitcnt lgkmcnt(9)
v_mfma_f32_16x16x32_bf16 v[56:59], v[96:99], a[220:223], 0
ds_read_b128 a[216:219], v16 offset:576
s_waitcnt lgkmcnt(9)
v_mfma_f32_16x16x32_bf16 v[60:63], v[96:99], a[252:255], 0
ds_read_b128 a[248:251], v16 offset:64
ds_read_b64 v[104:105], v13 offset:128
ds_read_b64 v[106:107], v13 offset:136
s_waitcnt lgkmcnt(10)
s_waitcnt lgkmcnt(9)
v_mfma_f32_16x16x32_bf16 v[32:35], v[100:103], a[24:27], v[32:35]
ds_read_b128 a[20:23], v16 offset:3712
s_waitcnt lgkmcnt(9)
v_mfma_f32_16x16x32_bf16 v[36:39], v[100:103], a[56:59], v[36:39]
ds_read_b128 a[52:55], v16 offset:3200
s_waitcnt lgkmcnt(9)
v_mfma_f32_16x16x32_bf16 v[40:43], v[100:103], a[88:91], v[40:43]
ds_read_b128 a[84:87], v16 offset:2688
s_waitcnt lgkmcnt(9)
v_mfma_f32_16x16x32_bf16 v[44:47], v[100:103], a[120:123], v[44:47]
ds_read_b128 a[116:119], v16 offset:2176
s_waitcnt lgkmcnt(9)
v_mfma_f32_16x16x32_bf16 v[48:51], v[100:103], a[152:155], v[48:51]
ds_read_b128 a[148:151], v16 offset:1664
s_waitcnt lgkmcnt(9)
v_mfma_f32_16x16x32_bf16 v[52:55], v[100:103], a[184:187], v[52:55]
ds_read_b128 a[180:183], v16 offset:1152
s_waitcnt lgkmcnt(9)
v_mfma_f32_16x16x32_bf16 v[56:59], v[100:103], a[216:219], v[56:59]
ds_read_b128 a[212:215], v16 offset:640
s_waitcnt lgkmcnt(9)
v_mfma_f32_16x16x32_bf16 v[60:63], v[100:103], a[248:251], v[60:63]
ds_read_b128 a[244:247], v16 offset:128
ds_read_b64 v[108:109], v13 offset:192
ds_read_b64 v[110:111], v13 offset:200
s_waitcnt lgkmcnt(10)
s_waitcnt lgkmcnt(9)
v_mfma_f32_16x16x32_bf16 v[32:35], v[104:107], a[20:23], v[32:35]
ds_read_b128 a[16:19], v16 offset:3776
s_waitcnt lgkmcnt(9)
v_mfma_f32_16x16x32_bf16 v[36:39], v[104:107], a[52:55], v[36:39]
ds_read_b128 a[48:51], v16 offset:3264
s_waitcnt lgkmcnt(9)
v_mfma_f32_16x16x32_bf16 v[40:43], v[104:107], a[84:87], v[40:43]
ds_read_b128 a[80:83], v16 offset:2752
s_waitcnt lgkmcnt(9)
v_mfma_f32_16x16x32_bf16 v[44:47], v[104:107], a[116:119], v[44:47]
ds_read_b128 a[112:115], v16 offset:2240
s_waitcnt lgkmcnt(9)
v_mfma_f32_16x16x32_bf16 v[48:51], v[104:107], a[148:151], v[48:51]
ds_read_b128 a[144:147], v16 offset:1728
s_waitcnt lgkmcnt(9)
v_mfma_f32_16x16x32_bf16 v[52:55], v[104:107], a[180:183], v[52:55]
ds_read_b128 a[176:179], v16 offset:1216
s_waitcnt lgkmcnt(9)
v_mfma_f32_16x16x32_bf16 v[56:59], v[104:107], a[212:215], v[56:59]
ds_read_b128 a[208:211], v16 offset:704
s_waitcnt lgkmcnt(9)
v_mfma_f32_16x16x32_bf16 v[60:63], v[104:107], a[244:247], v[60:63]
ds_read_b128 a[240:243], v16 offset:192
ds_read_b64 v[112:113], v13 offset:256
ds_read_b64 v[114:115], v13 offset:264
s_waitcnt lgkmcnt(10)
s_waitcnt lgkmcnt(9)
v_mfma_f32_16x16x32_bf16 v[32:35], v[108:111], a[16:19], v[32:35]
ds_read_b128 a[12:15], v16 offset:3840
s_waitcnt lgkmcnt(9)
v_mfma_f32_16x16x32_bf16 v[36:39], v[108:111], a[48:51], v[36:39]
ds_read_b128 a[44:47], v16 offset:3328
s_waitcnt lgkmcnt(9)
v_mfma_f32_16x16x32_bf16 v[40:43], v[108:111], a[80:83], v[40:43]
ds_read_b128 a[76:79], v16 offset:2816
s_waitcnt lgkmcnt(9)
v_mfma_f32_16x16x32_bf16 v[44:47], v[108:111], a[112:115], v[44:47]
ds_read_b128 a[108:111], v16 offset:2304
s_waitcnt lgkmcnt(9)
v_mfma_f32_16x16x32_bf16 v[48:51], v[108:111], a[144:147], v[48:51]
ds_read_b128 a[140:143], v16 offset:1792
s_waitcnt lgkmcnt(9)
v_mfma_f32_16x16x32_bf16 v[52:55], v[108:111], a[176:179], v[52:55]
ds_read_b128 a[172:175], v16 offset:1280
s_waitcnt lgkmcnt(9)
v_mfma_f32_16x16x32_bf16 v[56:59], v[108:111], a[208:211], v[56:59]
ds_read_b128 a[204:207], v16 offset:768
s_waitcnt lgkmcnt(9)
v_mfma_f32_16x16x32_bf16 v[60:63], v[108:111], a[240:243], v[60:63]
ds_read_b128 a[236:239], v16 offset:256
ds_read_b64 v[116:117], v13 offset:320
ds_read_b64 v[118:119], v13 offset:328
s_waitcnt lgkmcnt(10)
s_waitcnt lgkmcnt(9)
v_mfma_f32_16x16x32_bf16 v[32:35], v[112:115], a[12:15], v[32:35]
ds_read_b128 a[8:11], v16 offset:3904
s_waitcnt lgkmcnt(9)
v_mfma_f32_16x16x32_bf16 v[36:39], v[112:115], a[44:47], v[36:39]
ds_read_b128 a[40:43], v16 offset:3392
s_waitcnt lgkmcnt(9)
v_mfma_f32_16x16x32_bf16 v[40:43], v[112:115], a[76:79], v[40:43]
ds_read_b128 a[72:75], v16 offset:2880
s_waitcnt lgkmcnt(9)
v_mfma_f32_16x16x32_bf16 v[44:47], v[112:115], a[108:111], v[44:47]
ds_read_b128 a[104:107], v16 offset:2368
s_waitcnt lgkmcnt(9)
v_mfma_f32_16x16x32_bf16 v[48:51], v[112:115], a[140:143], v[48:51]
ds_read_b128 a[136:139], v16 offset:1856
s_waitcnt lgkmcnt(9)
v_mfma_f32_16x16x32_bf16 v[52:55], v[112:115], a[172:175], v[52:55]
ds_read_b128 a[168:171], v16 offset:1344
s_waitcnt lgkmcnt(9)
v_mfma_f32_16x16x32_bf16 v[56:59], v[112:115], a[204:207], v[56:59]
ds_read_b128 a[200:203], v16 offset:832
s_waitcnt lgkmcnt(9)
v_mfma_f32_16x16x32_bf16 v[60:63], v[112:115], a[236:239], v[60:63]
ds_read_b128 a[232:235], v16 offset:320
ds_read_b64 v[96:97], v13 offset:384
ds_read_b64 v[98:99], v13 offset:392
s_waitcnt lgkmcnt(10)
s_waitcnt lgkmcnt(9)
v_mfma_f32_16x16x32_bf16 v[32:35], v[116:119], a[8:11], v[32:35]
ds_read_b128 a[4:7], v16 offset:3968
s_waitcnt lgkmcnt(9)
v_mfma_f32_16x16x32_bf16 v[36:39], v[116:119], a[40:43], v[36:39]
ds_read_b128 a[36:39], v16 offset:3456
s_waitcnt lgkmcnt(9)
v_mfma_f32_16x16x32_bf16 v[40:43], v[116:119], a[72:75], v[40:43]
ds_read_b128 a[68:71], v16 offset:2944
s_waitcnt lgkmcnt(9)
v_mfma_f32_16x16x32_bf16 v[44:47], v[116:119], a[104:107], v[44:47]
ds_read_b128 a[100:103], v16 offset:2432
s_waitcnt lgkmcnt(9)
v_mfma_f32_16x16x32_bf16 v[48:51], v[116:119], a[136:139], v[48:51]
ds_read_b128 a[132:135], v16 offset:1920
s_waitcnt lgkmcnt(9)
v_mfma_f32_16x16x32_bf16 v[52:55], v[116:119], a[168:171], v[52:55]
ds_read_b128 a[164:167], v16 offset:1408
s_waitcnt lgkmcnt(9)
v_mfma_f32_16x16x32_bf16 v[56:59], v[116:119], a[200:203], v[56:59]
ds_read_b128 a[196:199], v16 offset:896
s_waitcnt lgkmcnt(9)
v_mfma_f32_16x16x32_bf16 v[60:63], v[116:119], a[232:235], v[60:63]
ds_read_b128 a[228:231], v16 offset:384
ds_read_b64 v[100:101], v13 offset:448
ds_read_b64 v[102:103], v13 offset:456
s_waitcnt lgkmcnt(10)
s_waitcnt lgkmcnt(9)
v_mfma_f32_16x16x32_bf16 v[32:35], v[96:99], a[4:7], v[32:35]
ds_read_b128 a[0:3], v16 offset:4032
s_waitcnt lgkmcnt(9)
v_mfma_f32_16x16x32_bf16 v[36:39], v[96:99], a[36:39], v[36:39]
ds_read_b128 a[32:35], v16 offset:3520
s_waitcnt lgkmcnt(9)
v_mfma_f32_16x16x32_bf16 v[40:43], v[96:99], a[68:71], v[40:43]
ds_read_b128 a[64:67], v16 offset:3008
s_waitcnt lgkmcnt(9)
v_mfma_f32_16x16x32_bf16 v[44:47], v[96:99], a[100:103], v[44:47]
ds_read_b128 a[96:99], v16 offset:2496
s_waitcnt lgkmcnt(9)
v_mfma_f32_16x16x32_bf16 v[48:51], v[96:99], a[132:135], v[48:51]
ds_read_b128 a[128:131], v16 offset:1984
s_waitcnt lgkmcnt(9)
v_mfma_f32_16x16x32_bf16 v[52:55], v[96:99], a[164:167], v[52:55]
ds_read_b128 a[160:163], v16 offset:1472
s_waitcnt lgkmcnt(9)
v_mfma_f32_16x16x32_bf16 v[56:59], v[96:99], a[196:199], v[56:59]
ds_read_b128 a[192:195], v16 offset:960
s_waitcnt lgkmcnt(9)
v_mfma_f32_16x16x32_bf16 v[60:63], v[96:99], a[228:231], v[60:63]
ds_read_b128 a[224:227], v16 offset:448
ds_read_b64 v[104:105], v13 offset:512
ds_read_b64 v[106:107], v13 offset:520
s_waitcnt lgkmcnt(10)
s_waitcnt lgkmcnt(9)
v_mfma_f32_16x16x32_bf16 v[32:35], v[100:103], a[0:3], v[32:35]
ds_read_b64 v[108:109], v13 offset:576
ds_read_b64 v[110:111], v13 offset:584
s_waitcnt lgkmcnt(10)
v_mfma_f32_16x16x32_bf16 v[36:39], v[100:103], a[32:35], v[36:39]
s_waitcnt lgkmcnt(9)
v_mfma_f32_16x16x32_bf16 v[40:43], v[100:103], a[64:67], v[40:43]
s_waitcnt lgkmcnt(8)
v_mfma_f32_16x16x32_bf16 v[44:47], v[100:103], a[96:99], v[44:47]
s_waitcnt lgkmcnt(7)
v_mfma_f32_16x16x32_bf16 v[48:51], v[100:103], a[128:131], v[48:51]
s_waitcnt lgkmcnt(6)
v_mfma_f32_16x16x32_bf16 v[52:55], v[100:103], a[160:163], v[52:55]
s_waitcnt lgkmcnt(5)
v_mfma_f32_16x16x32_bf16 v[56:59], v[100:103], a[192:195], v[56:59]
s_waitcnt lgkmcnt(4)
v_mfma_f32_16x16x32_bf16 v[60:63], v[100:103], a[224:227], v[60:63]
s_waitcnt lgkmcnt(2)
v_mfma_f32_16x16x32_bf16 v[36:39], v[104:107], a[28:31], v[36:39]
ds_read_b64 v[112:113], v13 offset:640
ds_read_b64 v[114:115], v13 offset:648
v_mfma_f32_16x16x32_bf16 v[40:43], v[104:107], a[60:63], v[40:43]
v_mfma_f32_16x16x32_bf16 v[44:47], v[104:107], a[92:95], v[44:47]
v_mfma_f32_16x16x32_bf16 v[48:51], v[104:107], a[124:127], v[48:51]
v_mfma_f32_16x16x32_bf16 v[52:55], v[104:107], a[156:159], v[52:55]
v_mfma_f32_16x16x32_bf16 v[56:59], v[104:107], a[188:191], v[56:59]
v_mfma_f32_16x16x32_bf16 v[60:63], v[104:107], a[220:223], v[60:63]
s_waitcnt vmcnt(0)
v_mov_b32 v4, 0
v_mov_b32 v5, 2
v_cmp_eq_u32 vcc, 0, v1
s_and_saveexec_b64 s[40:41], vcc
buffer_store_dword v5, v4, s[12:15], s56 offen sc1
s_mov_b64 exec, s[40:41]
s_waitcnt lgkmcnt(2)
v_mfma_f32_16x16x32_bf16 v[36:39], v[108:111], a[24:27], v[36:39]
ds_read_b64 v[116:117], v13 offset:704
ds_read_b64 v[118:119], v13 offset:712
v_mfma_f32_16x16x32_bf16 v[40:43], v[108:111], a[56:59], v[40:43]
v_mfma_f32_16x16x32_bf16 v[44:47], v[108:111], a[88:91], v[44:47]
v_mfma_f32_16x16x32_bf16 v[48:51], v[108:111], a[120:123], v[48:51]
v_mfma_f32_16x16x32_bf16 v[52:55], v[108:111], a[152:155], v[52:55]
v_mfma_f32_16x16x32_bf16 v[56:59], v[108:111], a[184:187], v[56:59]
v_mfma_f32_16x16x32_bf16 v[60:63], v[108:111], a[216:219], v[60:63]
s_waitcnt lgkmcnt(2)
v_mfma_f32_16x16x32_bf16 v[36:39], v[112:115], a[20:23], v[36:39]
ds_read_b64 v[96:97], v13 offset:768
ds_read_b64 v[98:99], v13 offset:776
v_mfma_f32_16x16x32_bf16 v[40:43], v[112:115], a[52:55], v[40:43]
v_mfma_f32_16x16x32_bf16 v[44:47], v[112:115], a[84:87], v[44:47]
v_mfma_f32_16x16x32_bf16 v[48:51], v[112:115], a[116:119], v[48:51]
v_mfma_f32_16x16x32_bf16 v[52:55], v[112:115], a[148:151], v[52:55]
v_mfma_f32_16x16x32_bf16 v[56:59], v[112:115], a[180:183], v[56:59]
v_mfma_f32_16x16x32_bf16 v[60:63], v[112:115], a[212:215], v[60:63]
s_waitcnt lgkmcnt(2)
v_mfma_f32_16x16x32_bf16 v[36:39], v[116:119], a[16:19], v[36:39]
ds_read_b64 v[100:101], v13 offset:832
ds_read_b64 v[102:103], v13 offset:840
v_mfma_f32_16x16x32_bf16 v[40:43], v[116:119], a[48:51], v[40:43]
v_mfma_f32_16x16x32_bf16 v[44:47], v[116:119], a[80:83], v[44:47]
v_mfma_f32_16x16x32_bf16 v[48:51], v[116:119], a[112:115], v[48:51]
v_mfma_f32_16x16x32_bf16 v[52:55], v[116:119], a[144:147], v[52:55]
v_mfma_f32_16x16x32_bf16 v[56:59], v[116:119], a[176:179], v[56:59]
v_mfma_f32_16x16x32_bf16 v[60:63], v[116:119], a[208:211], v[60:63]
s_waitcnt lgkmcnt(2)
v_mfma_f32_16x16x32_bf16 v[36:39], v[96:99], a[12:15], v[36:39]
ds_read_b64 v[104:105], v13 offset:896
ds_read_b64 v[106:107], v13 offset:904
v_mfma_f32_16x16x32_bf16 v[40:43], v[96:99], a[44:47], v[40:43]
v_mfma_f32_16x16x32_bf16 v[44:47], v[96:99], a[76:79], v[44:47]
v_mfma_f32_16x16x32_bf16 v[48:51], v[96:99], a[108:111], v[48:51]
v_mfma_f32_16x16x32_bf16 v[52:55], v[96:99], a[140:143], v[52:55]
v_mfma_f32_16x16x32_bf16 v[56:59], v[96:99], a[172:175], v[56:59]
v_mfma_f32_16x16x32_bf16 v[60:63], v[96:99], a[204:207], v[60:63]
s_waitcnt lgkmcnt(2)
v_mfma_f32_16x16x32_bf16 v[36:39], v[100:103], a[8:11], v[36:39]
ds_read_b64 v[108:109], v13 offset:960
ds_read_b64 v[110:111], v13 offset:968
v_mfma_f32_16x16x32_bf16 v[40:43], v[100:103], a[40:43], v[40:43]
v_mfma_f32_16x16x32_bf16 v[44:47], v[100:103], a[72:75], v[44:47]
v_mfma_f32_16x16x32_bf16 v[48:51], v[100:103], a[104:107], v[48:51]
v_mfma_f32_16x16x32_bf16 v[52:55], v[100:103], a[136:139], v[52:55]
v_mfma_f32_16x16x32_bf16 v[56:59], v[100:103], a[168:171], v[56:59]
v_mfma_f32_16x16x32_bf16 v[60:63], v[100:103], a[200:203], v[60:63]
s_waitcnt lgkmcnt(2)
v_mfma_f32_16x16x32_bf16 v[36:39], v[104:107], a[4:7], v[36:39]
ds_read_b64 v[112:113], v13 offset:1024
ds_read_b64 v[114:115], v13 offset:1032
v_mfma_f32_16x16x32_bf16 v[40:43], v[104:107], a[36:39], v[40:43]
v_mfma_f32_16x16x32_bf16 v[44:47], v[104:107], a[68:71], v[44:47]
v_mfma_f32_16x16x32_bf16 v[48:51], v[104:107], a[100:103], v[48:51]
v_mfma_f32_16x16x32_bf16 v[52:55], v[104:107], a[132:135], v[52:55]
v_mfma_f32_16x16x32_bf16 v[56:59], v[104:107], a[164:167], v[56:59]
v_mfma_f32_16x16x32_bf16 v[60:63], v[104:107], a[196:199], v[60:63]
s_waitcnt lgkmcnt(2)
v_mfma_f32_16x16x32_bf16 v[36:39], v[108:111], a[0:3], v[36:39]
ds_read_b64 v[116:117], v13 offset:1088
ds_read_b64 v[118:119], v13 offset:1096
v_mfma_f32_16x16x32_bf16 v[40:43], v[108:111], a[32:35], v[40:43]
v_mfma_f32_16x16x32_bf16 v[44:47], v[108:111], a[64:67], v[44:47]
v_mfma_f32_16x16x32_bf16 v[48:51], v[108:111], a[96:99], v[48:51]
v_mfma_f32_16x16x32_bf16 v[52:55], v[108:111], a[128:131], v[52:55]
v_mfma_f32_16x16x32_bf16 v[56:59], v[108:111], a[160:163], v[56:59]
v_mfma_f32_16x16x32_bf16 v[60:63], v[108:111], a[192:195], v[60:63]
s_waitcnt lgkmcnt(2)
v_mfma_f32_16x16x32_bf16 v[40:43], v[112:115], a[28:31], v[40:43]
ds_read_b64 v[96:97], v13 offset:1152
ds_read_b64 v[98:99], v13 offset:1160
v_mfma_f32_16x16x32_bf16 v[44:47], v[112:115], a[60:63], v[44:47]
v_mfma_f32_16x16x32_bf16 v[48:51], v[112:115], a[92:95], v[48:51]
v_mfma_f32_16x16x32_bf16 v[52:55], v[112:115], a[124:127], v[52:55]
v_mfma_f32_16x16x32_bf16 v[56:59], v[112:115], a[156:159], v[56:59]
v_mfma_f32_16x16x32_bf16 v[60:63], v[112:115], a[188:191], v[60:63]
s_waitcnt lgkmcnt(2)
v_mfma_f32_16x16x32_bf16 v[40:43], v[116:119], a[24:27], v[40:43]
ds_read_b64 v[100:101], v13 offset:1216
ds_read_b64 v[102:103], v13 offset:1224
v_mfma_f32_16x16x32_bf16 v[44:47], v[116:119], a[56:59], v[44:47]
v_mfma_f32_16x16x32_bf16 v[48:51], v[116:119], a[88:91], v[48:51]
v_mfma_f32_16x16x32_bf16 v[52:55], v[116:119], a[120:123], v[52:55]
v_mfma_f32_16x16x32_bf16 v[56:59], v[116:119], a[152:155], v[56:59]
v_mfma_f32_16x16x32_bf16 v[60:63], v[116:119], a[184:187], v[60:63]
s_waitcnt lgkmcnt(2)
v_mfma_f32_16x16x32_bf16 v[40:43], v[96:99], a[20:23], v[40:43]
ds_read_b64 v[104:105], v13 offset:1280
ds_read_b64 v[106:107], v13 offset:1288
v_mfma_f32_16x16x32_bf16 v[44:47], v[96:99], a[52:55], v[44:47]
v_mfma_f32_16x16x32_bf16 v[48:51], v[96:99], a[84:87], v[48:51]
v_mfma_f32_16x16x32_bf16 v[52:55], v[96:99], a[116:119], v[52:55]
v_mfma_f32_16x16x32_bf16 v[56:59], v[96:99], a[148:151], v[56:59]
v_mfma_f32_16x16x32_bf16 v[60:63], v[96:99], a[180:183], v[60:63]
s_waitcnt lgkmcnt(2)
v_mfma_f32_16x16x32_bf16 v[40:43], v[100:103], a[16:19], v[40:43]
ds_read_b64 v[108:109], v13 offset:1344
ds_read_b64 v[110:111], v13 offset:1352
v_mfma_f32_16x16x32_bf16 v[44:47], v[100:103], a[48:51], v[44:47]
v_mfma_f32_16x16x32_bf16 v[48:51], v[100:103], a[80:83], v[48:51]
v_mfma_f32_16x16x32_bf16 v[52:55], v[100:103], a[112:115], v[52:55]
v_mfma_f32_16x16x32_bf16 v[56:59], v[100:103], a[144:147], v[56:59]
v_mfma_f32_16x16x32_bf16 v[60:63], v[100:103], a[176:179], v[60:63]
s_waitcnt lgkmcnt(2)
v_mfma_f32_16x16x32_bf16 v[40:43], v[104:107], a[12:15], v[40:43]
ds_read_b64 v[112:113], v13 offset:1408
ds_read_b64 v[114:115], v13 offset:1416
v_mfma_f32_16x16x32_bf16 v[44:47], v[104:107], a[44:47], v[44:47]
v_mfma_f32_16x16x32_bf16 v[48:51], v[104:107], a[76:79], v[48:51]
v_mfma_f32_16x16x32_bf16 v[52:55], v[104:107], a[108:111], v[52:55]
v_mfma_f32_16x16x32_bf16 v[56:59], v[104:107], a[140:143], v[56:59]
v_mfma_f32_16x16x32_bf16 v[60:63], v[104:107], a[172:175], v[60:63]
s_waitcnt lgkmcnt(2)
v_mfma_f32_16x16x32_bf16 v[40:43], v[108:111], a[8:11], v[40:43]
ds_read_b64 v[116:117], v13 offset:1472
ds_read_b64 v[118:119], v13 offset:1480
v_mfma_f32_16x16x32_bf16 v[44:47], v[108:111], a[40:43], v[44:47]
v_mfma_f32_16x16x32_bf16 v[48:51], v[108:111], a[72:75], v[48:51]
v_mfma_f32_16x16x32_bf16 v[52:55], v[108:111], a[104:107], v[52:55]
v_mfma_f32_16x16x32_bf16 v[56:59], v[108:111], a[136:139], v[56:59]
v_mfma_f32_16x16x32_bf16 v[60:63], v[108:111], a[168:171], v[60:63]
s_waitcnt lgkmcnt(2)
v_mfma_f32_16x16x32_bf16 v[40:43], v[112:115], a[4:7], v[40:43]
ds_read_b64 v[96:97], v13 offset:1536
ds_read_b64 v[98:99], v13 offset:1544
v_mfma_f32_16x16x32_bf16 v[44:47], v[112:115], a[36:39], v[44:47]
v_mfma_f32_16x16x32_bf16 v[48:51], v[112:115], a[68:71], v[48:51]
v_mfma_f32_16x16x32_bf16 v[52:55], v[112:115], a[100:103], v[52:55]
v_mfma_f32_16x16x32_bf16 v[56:59], v[112:115], a[132:135], v[56:59]
v_mfma_f32_16x16x32_bf16 v[60:63], v[112:115], a[164:167], v[60:63]
s_waitcnt lgkmcnt(2)
v_mfma_f32_16x16x32_bf16 v[40:43], v[116:119], a[0:3], v[40:43]
ds_read_b64 v[100:101], v13 offset:1600
ds_read_b64 v[102:103], v13 offset:1608
v_mfma_f32_16x16x32_bf16 v[44:47], v[116:119], a[32:35], v[44:47]
v_mfma_f32_16x16x32_bf16 v[48:51], v[116:119], a[64:67], v[48:51]
v_mfma_f32_16x16x32_bf16 v[52:55], v[116:119], a[96:99], v[52:55]
v_mfma_f32_16x16x32_bf16 v[56:59], v[116:119], a[128:131], v[56:59]
v_mfma_f32_16x16x32_bf16 v[60:63], v[116:119], a[160:163], v[60:63]
s_waitcnt lgkmcnt(2)
v_mfma_f32_16x16x32_bf16 v[44:47], v[96:99], a[28:31], v[44:47]
ds_read_b64 v[104:105], v13 offset:1664
ds_read_b64 v[106:107], v13 offset:1672
v_mfma_f32_16x16x32_bf16 v[48:51], v[96:99], a[60:63], v[48:51]
v_mfma_f32_16x16x32_bf16 v[52:55], v[96:99], a[92:95], v[52:55]
v_mfma_f32_16x16x32_bf16 v[56:59], v[96:99], a[124:127], v[56:59]
v_mfma_f32_16x16x32_bf16 v[60:63], v[96:99], a[156:159], v[60:63]
s_waitcnt lgkmcnt(2)
v_mfma_f32_16x16x32_bf16 v[44:47], v[100:103], a[24:27], v[44:47]
ds_read_b64 v[108:109], v13 offset:1728
ds_read_b64 v[110:111], v13 offset:1736
v_mfma_f32_16x16x32_bf16 v[48:51], v[100:103], a[56:59], v[48:51]
v_mfma_f32_16x16x32_bf16 v[52:55], v[100:103], a[88:91], v[52:55]
v_mfma_f32_16x16x32_bf16 v[56:59], v[100:103], a[120:123], v[56:59]
v_mfma_f32_16x16x32_bf16 v[60:63], v[100:103], a[152:155], v[60:63]
s_waitcnt lgkmcnt(2)
v_mfma_f32_16x16x32_bf16 v[44:47], v[104:107], a[20:23], v[44:47]
ds_read_b64 v[112:113], v13 offset:1792
ds_read_b64 v[114:115], v13 offset:1800
v_mfma_f32_16x16x32_bf16 v[48:51], v[104:107], a[52:55], v[48:51]
v_mfma_f32_16x16x32_bf16 v[52:55], v[104:107], a[84:87], v[52:55]
v_mfma_f32_16x16x32_bf16 v[56:59], v[104:107], a[116:119], v[56:59]
v_mfma_f32_16x16x32_bf16 v[60:63], v[104:107], a[148:151], v[60:63]
s_waitcnt lgkmcnt(2)
v_mfma_f32_16x16x32_bf16 v[44:47], v[108:111], a[16:19], v[44:47]
ds_read_b64 v[116:117], v13 offset:1856
ds_read_b64 v[118:119], v13 offset:1864
v_mfma_f32_16x16x32_bf16 v[48:51], v[108:111], a[48:51], v[48:51]
v_mfma_f32_16x16x32_bf16 v[52:55], v[108:111], a[80:83], v[52:55]
v_mfma_f32_16x16x32_bf16 v[56:59], v[108:111], a[112:115], v[56:59]
v_mfma_f32_16x16x32_bf16 v[60:63], v[108:111], a[144:147], v[60:63]
s_waitcnt lgkmcnt(2)
v_mfma_f32_16x16x32_bf16 v[44:47], v[112:115], a[12:15], v[44:47]
ds_read_b64 v[96:97], v13 offset:1920
ds_read_b64 v[98:99], v13 offset:1928
v_mfma_f32_16x16x32_bf16 v[48:51], v[112:115], a[44:47], v[48:51]
v_mfma_f32_16x16x32_bf16 v[52:55], v[112:115], a[76:79], v[52:55]
v_mfma_f32_16x16x32_bf16 v[56:59], v[112:115], a[108:111], v[56:59]
v_mfma_f32_16x16x32_bf16 v[60:63], v[112:115], a[140:143], v[60:63]
s_waitcnt lgkmcnt(2)
v_mfma_f32_16x16x32_bf16 v[44:47], v[116:119], a[8:11], v[44:47]
ds_read_b64 v[100:101], v13 offset:1984
ds_read_b64 v[102:103], v13 offset:1992
v_mfma_f32_16x16x32_bf16 v[48:51], v[116:119], a[40:43], v[48:51]
v_mfma_f32_16x16x32_bf16 v[52:55], v[116:119], a[72:75], v[52:55]
v_mfma_f32_16x16x32_bf16 v[56:59], v[116:119], a[104:107], v[56:59]
v_mfma_f32_16x16x32_bf16 v[60:63], v[116:119], a[136:139], v[60:63]
s_waitcnt lgkmcnt(2)
v_mfma_f32_16x16x32_bf16 v[44:47], v[96:99], a[4:7], v[44:47]
ds_read_b64 v[104:105], v13 offset:2048
ds_read_b64 v[106:107], v13 offset:2056
v_mfma_f32_16x16x32_bf16 v[48:51], v[96:99], a[36:39], v[48:51]
v_mfma_f32_16x16x32_bf16 v[52:55], v[96:99], a[68:71], v[52:55]
v_mfma_f32_16x16x32_bf16 v[56:59], v[96:99], a[100:103], v[56:59]
v_mfma_f32_16x16x32_bf16 v[60:63], v[96:99], a[132:135], v[60:63]
s_waitcnt lgkmcnt(2)
v_mfma_f32_16x16x32_bf16 v[44:47], v[100:103], a[0:3], v[44:47]
ds_read_b64 v[108:109], v13 offset:2112
ds_read_b64 v[110:111], v13 offset:2120
v_mfma_f32_16x16x32_bf16 v[48:51], v[100:103], a[32:35], v[48:51]
v_mfma_f32_16x16x32_bf16 v[52:55], v[100:103], a[64:67], v[52:55]
v_mfma_f32_16x16x32_bf16 v[56:59], v[100:103], a[96:99], v[56:59]
v_mfma_f32_16x16x32_bf16 v[60:63], v[100:103], a[128:131], v[60:63]
s_waitcnt lgkmcnt(2)
v_mfma_f32_16x16x32_bf16 v[48:51], v[104:107], a[28:31], v[48:51]
ds_read_b64 v[112:113], v13 offset:2176
ds_read_b64 v[114:115], v13 offset:2184
v_mfma_f32_16x16x32_bf16 v[52:55], v[104:107], a[60:63], v[52:55]
v_mfma_f32_16x16x32_bf16 v[56:59], v[104:107], a[92:95], v[56:59]
v_mfma_f32_16x16x32_bf16 v[60:63], v[104:107], a[124:127], v[60:63]
s_waitcnt lgkmcnt(2)
v_mfma_f32_16x16x32_bf16 v[48:51], v[108:111], a[24:27], v[48:51]
ds_read_b64 v[116:117], v13 offset:2240
ds_read_b64 v[118:119], v13 offset:2248
v_mfma_f32_16x16x32_bf16 v[52:55], v[108:111], a[56:59], v[52:55]
v_mfma_f32_16x16x32_bf16 v[56:59], v[108:111], a[88:91], v[56:59]
v_mfma_f32_16x16x32_bf16 v[60:63], v[108:111], a[120:123], v[60:63]
s_waitcnt lgkmcnt(2)
v_mfma_f32_16x16x32_bf16 v[48:51], v[112:115], a[20:23], v[48:51]
ds_read_b64 v[96:97], v13 offset:2304
ds_read_b64 v[98:99], v13 offset:2312
v_mfma_f32_16x16x32_bf16 v[52:55], v[112:115], a[52:55], v[52:55]
v_mfma_f32_16x16x32_bf16 v[56:59], v[112:115], a[84:87], v[56:59]
v_mfma_f32_16x16x32_bf16 v[60:63], v[112:115], a[116:119], v[60:63]
s_waitcnt lgkmcnt(2)
v_mfma_f32_16x16x32_bf16 v[48:51], v[116:119], a[16:19], v[48:51]
ds_read_b64 v[100:101], v13 offset:2368
ds_read_b64 v[102:103], v13 offset:2376
v_mfma_f32_16x16x32_bf16 v[52:55], v[116:119], a[48:51], v[52:55]
v_mfma_f32_16x16x32_bf16 v[56:59], v[116:119], a[80:83], v[56:59]
v_mfma_f32_16x16x32_bf16 v[60:63], v[116:119], a[112:115], v[60:63]
s_waitcnt lgkmcnt(2)
v_mfma_f32_16x16x32_bf16 v[48:51], v[96:99], a[12:15], v[48:51]
ds_read_b64 v[104:105], v13 offset:2432
ds_read_b64 v[106:107], v13 offset:2440
v_mfma_f32_16x16x32_bf16 v[52:55], v[96:99], a[44:47], v[52:55]
v_mfma_f32_16x16x32_bf16 v[56:59], v[96:99], a[76:79], v[56:59]
v_mfma_f32_16x16x32_bf16 v[60:63], v[96:99], a[108:111], v[60:63]
s_waitcnt lgkmcnt(2)
v_mfma_f32_16x16x32_bf16 v[48:51], v[100:103], a[8:11], v[48:51]
ds_read_b64 v[108:109], v13 offset:2496
ds_read_b64 v[110:111], v13 offset:2504
v_mfma_f32_16x16x32_bf16 v[52:55], v[100:103], a[40:43], v[52:55]
v_mfma_f32_16x16x32_bf16 v[56:59], v[100:103], a[72:75], v[56:59]
v_mfma_f32_16x16x32_bf16 v[60:63], v[100:103], a[104:107], v[60:63]
s_waitcnt lgkmcnt(2)
v_mfma_f32_16x16x32_bf16 v[48:51], v[104:107], a[4:7], v[48:51]
ds_read_b64 v[112:113], v13 offset:2560
ds_read_b64 v[114:115], v13 offset:2568
v_mfma_f32_16x16x32_bf16 v[52:55], v[104:107], a[36:39], v[52:55]
v_mfma_f32_16x16x32_bf16 v[56:59], v[104:107], a[68:71], v[56:59]
v_mfma_f32_16x16x32_bf16 v[60:63], v[104:107], a[100:103], v[60:63]
s_waitcnt lgkmcnt(2)
v_mfma_f32_16x16x32_bf16 v[48:51], v[108:111], a[0:3], v[48:51]
ds_read_b64 v[116:117], v13 offset:2624
ds_read_b64 v[118:119], v13 offset:2632
v_mfma_f32_16x16x32_bf16 v[52:55], v[108:111], a[32:35], v[52:55]
v_mfma_f32_16x16x32_bf16 v[56:59], v[108:111], a[64:67], v[56:59]
v_mfma_f32_16x16x32_bf16 v[60:63], v[108:111], a[96:99], v[60:63]
s_waitcnt lgkmcnt(2)
v_mfma_f32_16x16x32_bf16 v[52:55], v[112:115], a[28:31], v[52:55]
ds_read_b64 v[96:97], v13 offset:2688
ds_read_b64 v[98:99], v13 offset:2696
v_mfma_f32_16x16x32_bf16 v[56:59], v[112:115], a[60:63], v[56:59]
v_mfma_f32_16x16x32_bf16 v[60:63], v[112:115], a[92:95], v[60:63]
s_waitcnt lgkmcnt(2)
v_mfma_f32_16x16x32_bf16 v[52:55], v[116:119], a[24:27], v[52:55]
ds_read_b64 v[100:101], v13 offset:2752
ds_read_b64 v[102:103], v13 offset:2760
v_mfma_f32_16x16x32_bf16 v[56:59], v[116:119], a[56:59], v[56:59]
v_mfma_f32_16x16x32_bf16 v[60:63], v[116:119], a[88:91], v[60:63]
s_waitcnt lgkmcnt(2)
v_mfma_f32_16x16x32_bf16 v[52:55], v[96:99], a[20:23], v[52:55]
ds_read_b64 v[104:105], v13 offset:2816
ds_read_b64 v[106:107], v13 offset:2824
v_mfma_f32_16x16x32_bf16 v[56:59], v[96:99], a[52:55], v[56:59]
v_mfma_f32_16x16x32_bf16 v[60:63], v[96:99], a[84:87], v[60:63]
s_waitcnt lgkmcnt(2)
v_mfma_f32_16x16x32_bf16 v[52:55], v[100:103], a[16:19], v[52:55]
ds_read_b64 v[108:109], v13 offset:2880
ds_read_b64 v[110:111], v13 offset:2888
v_mfma_f32_16x16x32_bf16 v[56:59], v[100:103], a[48:51], v[56:59]
v_mfma_f32_16x16x32_bf16 v[60:63], v[100:103], a[80:83], v[60:63]
s_waitcnt lgkmcnt(2)
v_mfma_f32_16x16x32_bf16 v[52:55], v[104:107], a[12:15], v[52:55]
ds_read_b64 v[112:113], v13 offset:2944
ds_read_b64 v[114:115], v13 offset:2952
v_mfma_f32_16x16x32_bf16 v[56:59], v[104:107], a[44:47], v[56:59]
v_mfma_f32_16x16x32_bf16 v[60:63], v[104:107], a[76:79], v[60:63]
s_waitcnt lgkmcnt(2)
v_mfma_f32_16x16x32_bf16 v[52:55], v[108:111], a[8:11], v[52:55]
ds_read_b64 v[116:117], v13 offset:3008
ds_read_b64 v[118:119], v13 offset:3016
v_mfma_f32_16x16x32_bf16 v[56:59], v[108:111], a[40:43], v[56:59]
v_mfma_f32_16x16x32_bf16 v[60:63], v[108:111], a[72:75], v[60:63]
s_waitcnt lgkmcnt(2)
v_mfma_f32_16x16x32_bf16 v[52:55], v[112:115], a[4:7], v[52:55]
ds_read_b64 v[96:97], v13 offset:3072
ds_read_b64 v[98:99], v13 offset:3080
v_mfma_f32_16x16x32_bf16 v[56:59], v[112:115], a[36:39], v[56:59]
v_mfma_f32_16x16x32_bf16 v[60:63], v[112:115], a[68:71], v[60:63]
s_waitcnt lgkmcnt(2)
v_mfma_f32_16x16x32_bf16 v[52:55], v[116:119], a[0:3], v[52:55]
ds_read_b64 v[100:101], v13 offset:3136
ds_read_b64 v[102:103], v13 offset:3144
v_mfma_f32_16x16x32_bf16 v[56:59], v[116:119], a[32:35], v[56:59]
v_mfma_f32_16x16x32_bf16 v[60:63], v[116:119], a[64:67], v[60:63]
s_waitcnt lgkmcnt(2)
v_mfma_f32_16x16x32_bf16 v[56:59], v[96:99], a[28:31], v[56:59]
ds_read_b64 v[104:105], v13 offset:3200
ds_read_b64 v[106:107], v13 offset:3208
v_mfma_f32_16x16x32_bf16 v[60:63], v[96:99], a[60:63], v[60:63]
s_waitcnt lgkmcnt(2)
v_mfma_f32_16x16x32_bf16 v[56:59], v[100:103], a[24:27], v[56:59]
ds_read_b64 v[108:109], v13 offset:3264
ds_read_b64 v[110:111], v13 offset:3272
v_mfma_f32_16x16x32_bf16 v[60:63], v[100:103], a[56:59], v[60:63]
s_waitcnt lgkmcnt(2)
v_mfma_f32_16x16x32_bf16 v[56:59], v[104:107], a[20:23], v[56:59]
ds_read_b64 v[112:113], v13 offset:3328
ds_read_b64 v[114:115], v13 offset:3336
v_mfma_f32_16x16x32_bf16 v[60:63], v[104:107], a[52:55], v[60:63]
s_waitcnt lgkmcnt(2)
v_mfma_f32_16x16x32_bf16 v[56:59], v[108:111], a[16:19], v[56:59]
ds_read_b64 v[116:117], v13 offset:3392
ds_read_b64 v[118:119], v13 offset:3400
v_mfma_f32_16x16x32_bf16 v[60:63], v[108:111], a[48:51], v[60:63]
s_waitcnt lgkmcnt(2)
v_mfma_f32_16x16x32_bf16 v[56:59], v[112:115], a[12:15], v[56:59]
ds_read_b64 v[96:97], v13 offset:3456
ds_read_b64 v[98:99], v13 offset:3464
v_mfma_f32_16x16x32_bf16 v[60:63], v[112:115], a[44:47], v[60:63]
s_waitcnt lgkmcnt(2)
v_mfma_f32_16x16x32_bf16 v[56:59], v[116:119], a[8:11], v[56:59]
ds_read_b64 v[100:101], v13 offset:3520
ds_read_b64 v[102:103], v13 offset:3528
v_mfma_f32_16x16x32_bf16 v[60:63], v[116:119], a[40:43], v[60:63]
s_waitcnt lgkmcnt(2)
v_mfma_f32_16x16x32_bf16 v[56:59], v[96:99], a[4:7], v[56:59]
ds_read_b64 v[104:105], v13 offset:3584
ds_read_b64 v[106:107], v13 offset:3592
v_mfma_f32_16x16x32_bf16 v[60:63], v[96:99], a[36:39], v[60:63]
s_waitcnt lgkmcnt(2)
v_mfma_f32_16x16x32_bf16 v[56:59], v[100:103], a[0:3], v[56:59]
ds_read_b64 v[108:109], v13 offset:3648
ds_read_b64 v[110:111], v13 offset:3656
v_mfma_f32_16x16x32_bf16 v[60:63], v[100:103], a[32:35], v[60:63]
s_waitcnt lgkmcnt(2)
v_mfma_f32_16x16x32_bf16 v[60:63], v[104:107], a[28:31], v[60:63]
ds_read_b64 v[112:113], v13 offset:3712
ds_read_b64 v[114:115], v13 offset:3720
s_waitcnt lgkmcnt(2)
v_mfma_f32_16x16x32_bf16 v[60:63], v[108:111], a[24:27], v[60:63]
ds_read_b64 v[116:117], v13 offset:3776
ds_read_b64 v[118:119], v13 offset:3784
s_waitcnt lgkmcnt(2)
v_mfma_f32_16x16x32_bf16 v[60:63], v[112:115], a[20:23], v[60:63]
ds_read_b64 v[96:97], v13 offset:3840
ds_read_b64 v[98:99], v13 offset:3848
s_waitcnt lgkmcnt(2)
v_mfma_f32_16x16x32_bf16 v[60:63], v[116:119], a[16:19], v[60:63]
ds_read_b64 v[100:101], v13 offset:3904
ds_read_b64 v[102:103], v13 offset:3912
s_waitcnt lgkmcnt(2)
v_mfma_f32_16x16x32_bf16 v[60:63], v[96:99], a[12:15], v[60:63]
ds_read_b64 v[104:105], v13 offset:3968
ds_read_b64 v[106:107], v13 offset:3976
s_waitcnt lgkmcnt(2)
v_mfma_f32_16x16x32_bf16 v[60:63], v[100:103], a[8:11], v[60:63]
ds_read_b64 v[108:109], v13 offset:4032
ds_read_b64 v[110:111], v13 offset:4040
s_waitcnt lgkmcnt(2)
v_mfma_f32_16x16x32_bf16 v[60:63], v[104:107], a[4:7], v[60:63]
s_waitcnt lgkmcnt(0)
v_mfma_f32_16x16x32_bf16 v[60:63], v[108:111], a[0:3], v[60:63]
v_lshlrev_b32 v5, 5, v14
v_lshlrev_b32 v17, 3, v15
v_add_u32 v17, v5, v17
s_add_u32 s76, s78, 504
v_sub_u32 v2, s76, v17
ds_read_b64 v[96:97], v2 offset:3584
ds_read_b64 v[98:99], v2 offset:3072
ds_read_b64 v[100:101], v2 offset:2560
ds_read_b64 v[102:103], v2 offset:2048
ds_read_b64 v[104:105], v2 offset:1536
ds_read_b64 v[106:107], v2 offset:1024
ds_read_b64 v[108:109], v2 offset:512
ds_read_b64 v[110:111], v2 offset:0
v_lshlrev_b32 v94, 16, v94
s_lshl_b32 s76, s70, 12
s_add_u32 s76, s76, 4784128
s_mov_b32 s77, 0xffff0000
s_waitcnt lgkmcnt(0)
v_and_b32 v112, s77, v97
v_lshlrev_b32 v113, 16, v97
v_and_b32 v114, s77, v96
v_lshlrev_b32 v115, 16, v96
v_fmac_f32 v32, v112, v94
v_fmac_f32 v33, v113, v94
v_fmac_f32 v34, v114, v94
v_fmac_f32 v35, v115, v94
v_cvt_pk_bf16_f32 v116, v32, v33
v_cvt_pk_bf16_f32 v117, v34, v35
buffer_store_dwordx2 v[116:117], v17, s[12:15], s76 offen sc1
v_and_b32 v118, s77, v99
v_lshlrev_b32 v119, 16, v99
v_and_b32 v120, s77, v98
v_lshlrev_b32 v121, 16, v98
v_fmac_f32 v36, v118, v94
v_fmac_f32 v37, v119, v94
v_fmac_f32 v38, v120, v94
v_fmac_f32 v39, v121, v94
v_cvt_pk_bf16_f32 v122, v36, v37
v_cvt_pk_bf16_f32 v123, v38, v39
buffer_store_dwordx2 v[122:123], v17, s[12:15], s76 offen offset:512 sc1
v_and_b32 v112, s77, v101
v_lshlrev_b32 v113, 16, v101
v_and_b32 v114, s77, v100
v_lshlrev_b32 v115, 16, v100
v_fmac_f32 v40, v112, v94
v_fmac_f32 v41, v113, v94
v_fmac_f32 v42, v114, v94
v_fmac_f32 v43, v115, v94
v_cvt_pk_bf16_f32 v116, v40, v41
v_cvt_pk_bf16_f32 v117, v42, v43
buffer_store_dwordx2 v[116:117], v17, s[12:15], s76 offen offset:1024 sc1
v_and_b32 v118, s77, v103
v_lshlrev_b32 v119, 16, v103
v_and_b32 v120, s77, v102
v_lshlrev_b32 v121, 16, v102
v_fmac_f32 v44, v118, v94
v_fmac_f32 v45, v119, v94
v_fmac_f32 v46, v120, v94
v_fmac_f32 v47, v121, v94
v_cvt_pk_bf16_f32 v122, v44, v45
v_cvt_pk_bf16_f32 v123, v46, v47
buffer_store_dwordx2 v[122:123], v17, s[12:15], s76 offen offset:1536 sc1
v_and_b32 v112, s77, v105
v_lshlrev_b32 v113, 16, v105
v_and_b32 v114, s77, v104
v_lshlrev_b32 v115, 16, v104
v_fmac_f32 v48, v112, v94
v_fmac_f32 v49, v113, v94
v_fmac_f32 v50, v114, v94
v_fmac_f32 v51, v115, v94
v_cvt_pk_bf16_f32 v116, v48, v49
v_cvt_pk_bf16_f32 v117, v50, v51
buffer_store_dwordx2 v[116:117], v17, s[12:15], s76 offen offset:2048 sc1
v_and_b32 v118, s77, v107
v_lshlrev_b32 v119, 16, v107
v_and_b32 v120, s77, v106
v_lshlrev_b32 v121, 16, v106
v_fmac_f32 v52, v118, v94
v_fmac_f32 v53, v119, v94
v_fmac_f32 v54, v120, v94
v_fmac_f32 v55, v121, v94
v_cvt_pk_bf16_f32 v122, v52, v53
v_cvt_pk_bf16_f32 v123, v54, v55
buffer_store_dwordx2 v[122:123], v17, s[12:15], s76 offen offset:2560 sc1
v_and_b32 v112, s77, v109
v_lshlrev_b32 v113, 16, v109
v_and_b32 v114, s77, v108
v_lshlrev_b32 v115, 16, v108
v_fmac_f32 v56, v112, v94
v_fmac_f32 v57, v113, v94
v_fmac_f32 v58, v114, v94
v_fmac_f32 v59, v115, v94
v_cvt_pk_bf16_f32 v116, v56, v57
v_cvt_pk_bf16_f32 v117, v58, v59
buffer_store_dwordx2 v[116:117], v17, s[12:15], s76 offen offset:3072 sc1
v_and_b32 v118, s77, v111
v_lshlrev_b32 v119, 16, v111
v_and_b32 v120, s77, v110
v_lshlrev_b32 v121, 16, v110
v_fmac_f32 v60, v118, v94
v_fmac_f32 v61, v119, v94
v_fmac_f32 v62, v120, v94
v_fmac_f32 v63, v121, v94
v_cvt_pk_bf16_f32 v122, v60, v61
v_cvt_pk_bf16_f32 v123, v62, v63
buffer_store_dwordx2 v[122:123], v17, s[12:15], s76 offen offset:3584 sc1
v_and_b32 v3, 15, v1
v_lshrrev_b32 v4, 4, v1
s_lshl_b32 s36, s22, 6
v_add_u32 v5, s36, v3
s_lshl_b32 s36, s57, 6
s_lshl_b32 s35, s55, 4
s_add_u32 s36, s36, s35
v_lshlrev_b32 v6, 2, v4
v_add_u32 v6, s36, v6
v_mul_u32_u24 v7, 1152, v5
v_lshl_add_u32 v7, v6, 1, v7
v_lshlrev_b32 v8, 12, v6
v_lshl_add_u32 v8, v5, 1, v8
v_add_u32 v8, 4784128, v8
v_lshlrev_b32 v9, 3, v5
v_add_u32 v9, 2359296, v9
s_mov_b32 s37, 0
buffer_load_dwordx2 v[208:209], v7, s[72:75], s37 offen
s_mov_b32 s37, 18432
buffer_load_dwordx2 v[210:211], v7, s[72:75], s37 offen
s_mov_b32 s37, 36864
buffer_load_dwordx2 v[212:213], v7, s[72:75], s37 offen
s_mov_b32 s37, 55296
buffer_load_dwordx2 v[214:215], v7, s[72:75], s37 offen
buffer_load_dwordx2 v[232:233], v9, s[12:15], 0 offen sc1
buffer_load_dwordx2 v[234:235], v9, s[12:15], 0 offen offset:128 sc1
buffer_load_dwordx2 v[236:237], v9, s[12:15], 0 offen offset:256 sc1
buffer_load_dwordx2 v[238:239], v9, s[12:15], 0 offen offset:384 sc1
s_cmp_lg_u32 s20, 0
s_cbranch_scc1 L_nosig
v_mov_b32 v2, 147456
v_mov_b32 v3, 1
ds_write_b32 v2, v3
L_nosig:
s_mov_b32 s54, 3
s_branch L_stg
L_noconv:
s_waitcnt vmcnt(0)
v_mov_b32 v4, 0
v_mov_b32 v5, 2
v_cmp_eq_u32 vcc, 0, v1
s_and_saveexec_b64 s[40:41], vcc
buffer_store_dword v5, v4, s[12:15], s56 offen sc1
s_mov_b64 exec, s[40:41]
s_mov_b32 s54, 3
s_cmp_eq_u32 s20, 3
s_cbranch_scc1 L_w3
v_and_b32 v3, 15, v1
v_lshrrev_b32 v4, 4, v1
s_lshl_b32 s36, s22, 6
v_add_u32 v5, s36, v3
s_lshl_b32 s36, s57, 6
s_lshl_b32 s35, s55, 4
s_add_u32 s36, s36, s35
v_lshlrev_b32 v6, 2, v4
v_add_u32 v6, s36, v6
v_mul_u32_u24 v7, 1152, v5
v_lshl_add_u32 v7, v6, 1, v7
v_lshlrev_b32 v8, 12, v6
v_lshl_add_u32 v8, v5, 1, v8
v_add_u32 v8, 4784128, v8
v_lshlrev_b32 v9, 3, v5
v_add_u32 v9, 2359296, v9
s_mov_b32 s37, 0
buffer_load_dwordx2 v[208:209], v7, s[72:75], s37 offen
s_mov_b32 s37, 18432
buffer_load_dwordx2 v[210:211], v7, s[72:75], s37 offen
s_mov_b32 s37, 36864
buffer_load_dwordx2 v[212:213], v7, s[72:75], s37 offen
s_mov_b32 s37, 55296
buffer_load_dwordx2 v[214:215], v7, s[72:75], s37 offen
buffer_load_dwordx2 v[232:233], v9, s[12:15], 0 offen sc1
buffer_load_dwordx2 v[234:235], v9, s[12:15], 0 offen offset:128 sc1
buffer_load_dwordx2 v[236:237], v9, s[12:15], 0 offen offset:256 sc1
buffer_load_dwordx2 v[238:239], v9, s[12:15], 0 offen offset:384 sc1
s_branch L_stg
L_w3:
s_lshl_b32 s34, s22, 7
s_add_u32 s34, s34, 7274496
v_and_b32 v12, 31, v1
v_lshlrev_b32 v12, 2, v12
v_add_u32 v12, s34, v12
s_mov_b32 s77, 0
L_poll_pB:
buffer_load_dword v3, v12, s[12:15], 0 offen sc1
s_waitcnt vmcnt(0)
v_cmp_le_u32 vcc, 1, v3
s_add_u32 s77, s77, 1
s_cmp_eq_u64 vcc, exec
s_cbranch_scc1 L_pollok_pB
s_cmp_lt_u32 s77, 20000
s_cbranch_scc0 L_pollok_pB
s_sleep 2
s_branch L_poll_pB
L_pollok_pB:
s_mul_i32 s36, s22, 9
s_add_u32 s36, s36, s21
s_mul_i32 s36, s36, 8192
s_add_u32 s36, s36, 7340032
s_mov_b32 m0, 0
s_add_u32 s37, s36, 0
buffer_load_dwordx4 v19, s[12:15], s37 offen sc1 lds
buffer_load_dwordx4 v19, s[12:15], s37 offen offset:1024 sc1 lds
buffer_load_dwordx4 v19, s[12:15], s37 offen offset:2048 sc1 lds
buffer_load_dwordx4 v19, s[12:15], s37 offen offset:3072 sc1 lds
s_mov_b32 m0, 4096
s_add_u32 s37, s36, 4096
buffer_load_dwordx4 v19, s[12:15], s37 offen sc1 lds
buffer_load_dwordx4 v19, s[12:15], s37 offen offset:1024 sc1 lds
buffer_load_dwordx4 v19, s[12:15], s37 offen offset:2048 sc1 lds
buffer_load_dwordx4 v19, s[12:15], s37 offen offset:3072 sc1 lds
s_add_u32 s36, s36, 2359296
s_mov_b32 m0, 8192
s_add_u32 s37, s36, 0
buffer_load_dwordx4 v19, s[12:15], s37 offen sc1 lds
buffer_load_dwordx4 v19, s[12:15], s37 offen offset:1024 sc1 lds
buffer_load_dwordx4 v19, s[12:15], s37 offen offset:2048 sc1 lds
buffer_load_dwordx4 v19, s[12:15], s37 offen offset:3072 sc1 lds
s_mov_b32 m0, 12288
s_add_u32 s37, s36, 4096
buffer_load_dwordx4 v19, s[12:15], s37 offen sc1 lds
buffer_load_dwordx4 v19, s[12:15], s37 offen offset:1024 sc1 lds
buffer_load_dwordx4 v19, s[12:15], s37 offen offset:2048 sc1 lds
buffer_load_dwordx4 v19, s[12:15], s37 offen offset:3072 sc1 lds
s_add_u32 s36, s36, 2359296
s_mov_b32 m0, 16384
s_add_u32 s37, s36, 0
buffer_load_dwordx4 v19, s[12:15], s37 offen sc1 lds
buffer_load_dwordx4 v19, s[12:15], s37 offen offset:1024 sc1 lds
buffer_load_dwordx4 v19, s[12:15], s37 offen offset:2048 sc1 lds
buffer_load_dwordx4 v19, s[12:15], s37 offen offset:3072 sc1 lds
s_mov_b32 m0, 20480
s_add_u32 s37, s36, 4096
buffer_load_dwordx4 v19, s[12:15], s37 offen sc1 lds
buffer_load_dwordx4 v19, s[12:15], s37 offen offset:1024 sc1 lds
buffer_load_dwordx4 v19, s[12:15], s37 offen offset:2048 sc1 lds
buffer_load_dwordx4 v19, s[12:15], s37 offen offset:3072 sc1 lds
s_add_u32 s36, s36, 2359296
s_mov_b32 m0, 24576
s_add_u32 s37, s36, 0
buffer_load_dwordx4 v19, s[12:15], s37 offen sc1 lds
buffer_load_dwordx4 v19, s[12:15], s37 offen offset:1024 sc1 lds
buffer_load_dwordx4 v19, s[12:15], s37 offen offset:2048 sc1 lds
buffer_load_dwordx4 v19, s[12:15], s37 offen offset:3072 sc1 lds
s_mov_b32 m0, 28672
s_add_u32 s37, s36, 4096
buffer_load_dwordx4 v19, s[12:15], s37 offen sc1 lds
buffer_load_dwordx4 v19, s[12:15], s37 offen offset:1024 sc1 lds
buffer_load_dwordx4 v19, s[12:15], s37 offen offset:2048 sc1 lds
buffer_load_dwordx4 v19, s[12:15], s37 offen offset:3072 sc1 lds
s_add_u32 s36, s36, 2359296
s_mov_b32 m0, 32768
s_add_u32 s37, s36, 0
buffer_load_dwordx4 v19, s[12:15], s37 offen sc1 lds
buffer_load_dwordx4 v19, s[12:15], s37 offen offset:1024 sc1 lds
buffer_load_dwordx4 v19, s[12:15], s37 offen offset:2048 sc1 lds
buffer_load_dwordx4 v19, s[12:15], s37 offen offset:3072 sc1 lds
s_mov_b32 m0, 36864
s_add_u32 s37, s36, 4096
buffer_load_dwordx4 v19, s[12:15], s37 offen sc1 lds
buffer_load_dwordx4 v19, s[12:15], s37 offen offset:1024 sc1 lds
buffer_load_dwordx4 v19, s[12:15], s37 offen offset:2048 sc1 lds
buffer_load_dwordx4 v19, s[12:15], s37 offen offset:3072 sc1 lds
s_add_u32 s36, s36, 2359296
s_mov_b32 m0, 40960
s_add_u32 s37, s36, 0
buffer_load_dwordx4 v19, s[12:15], s37 offen sc1 lds
buffer_load_dwordx4 v19, s[12:15], s37 offen offset:1024 sc1 lds
buffer_load_dwordx4 v19, s[12:15], s37 offen offset:2048 sc1 lds
buffer_load_dwordx4 v19, s[12:15], s37 offen offset:3072 sc1 lds
s_mov_b32 m0, 45056
s_add_u32 s37, s36, 4096
buffer_load_dwordx4 v19, s[12:15], s37 offen sc1 lds
buffer_load_dwordx4 v19, s[12:15], s37 offen offset:1024 sc1 lds
buffer_load_dwordx4 v19, s[12:15], s37 offen offset:2048 sc1 lds
buffer_load_dwordx4 v19, s[12:15], s37 offen offset:3072 sc1 lds
s_add_u32 s36, s36, 2359296
s_mov_b32 m0, 49152
s_add_u32 s37, s36, 0
buffer_load_dwordx4 v19, s[12:15], s37 offen sc1 lds
buffer_load_dwordx4 v19, s[12:15], s37 offen offset:1024 sc1 lds
buffer_load_dwordx4 v19, s[12:15], s37 offen offset:2048 sc1 lds
buffer_load_dwordx4 v19, s[12:15], s37 offen offset:3072 sc1 lds
s_mov_b32 m0, 53248
s_add_u32 s37, s36, 4096
buffer_load_dwordx4 v19, s[12:15], s37 offen sc1 lds
buffer_load_dwordx4 v19, s[12:15], s37 offen offset:1024 sc1 lds
buffer_load_dwordx4 v19, s[12:15], s37 offen offset:2048 sc1 lds
buffer_load_dwordx4 v19, s[12:15], s37 offen offset:3072 sc1 lds
s_add_u32 s36, s36, 2359296
s_mov_b32 m0, 57344
s_add_u32 s37, s36, 0
buffer_load_dwordx4 v19, s[12:15], s37 offen sc1 lds
buffer_load_dwordx4 v19, s[12:15], s37 offen offset:1024 sc1 lds
buffer_load_dwordx4 v19, s[12:15], s37 offen offset:2048 sc1 lds
buffer_load_dwordx4 v19, s[12:15], s37 offen offset:3072 sc1 lds
s_mov_b32 m0, 61440
s_add_u32 s37, s36, 4096
buffer_load_dwordx4 v19, s[12:15], s37 offen sc1 lds
buffer_load_dwordx4 v19, s[12:15], s37 offen offset:1024 sc1 lds
buffer_load_dwordx4 v19, s[12:15], s37 offen offset:2048 sc1 lds
buffer_load_dwordx4 v19, s[12:15], s37 offen offset:3072 sc1 lds
v_and_b32 v3, 15, v1
v_lshrrev_b32 v4, 4, v1
s_lshl_b32 s36, s22, 6
v_add_u32 v5, s36, v3
s_lshl_b32 s36, s57, 6
s_lshl_b32 s35, s55, 4
s_add_u32 s36, s36, s35
v_lshlrev_b32 v6, 2, v4
v_add_u32 v6, s36, v6
v_mul_u32_u24 v7, 1152, v5
v_lshl_add_u32 v7, v6, 1, v7
v_lshlrev_b32 v8, 12, v6
v_lshl_add_u32 v8, v5, 1, v8
v_add_u32 v8, 4784128, v8
v_lshlrev_b32 v9, 3, v5
v_add_u32 v9, 2359296, v9
s_mov_b32 s37, 0
buffer_load_dwordx2 v[208:209], v7, s[72:75], s37 offen
s_mov_b32 s37, 18432
buffer_load_dwordx2 v[210:211], v7, s[72:75], s37 offen
s_mov_b32 s37, 36864
buffer_load_dwordx2 v[212:213], v7, s[72:75], s37 offen
s_mov_b32 s37, 55296
buffer_load_dwordx2 v[214:215], v7, s[72:75], s37 offen
buffer_load_dwordx2 v[232:233], v9, s[12:15], 0 offen sc1
buffer_load_dwordx2 v[234:235], v9, s[12:15], 0 offen offset:128 sc1
buffer_load_dwordx2 v[236:237], v9, s[12:15], 0 offen offset:256 sc1
buffer_load_dwordx2 v[238:239], v9, s[12:15], 0 offen offset:384 sc1
s_waitcnt vmcnt(0)
v_mov_b32 v2, 147460
v_mov_b32 v3, 1
ds_write_b32 v2, v3
s_lshr_b32 s34, s21, 2
s_and_b32 s35, s22, 1
s_cmp_lg_u32 s34, s35
s_cbranch_scc1 L_stg
s_mov_b32 s54, 0
v_mov_b32 v100, v7
v_mov_b32 v101, v8
s_mov_b32 s57, 8
s_and_b32 s55, s21, 3
s_lshl_b32 s34, s22, 7
s_lshl_b32 s35, s55, 2
s_add_u32 s34, s34, s35
s_add_u32 s34, s34, 7274496
v_and_b32 v12, 7, v1
v_lshlrev_b32 v12, 4, v12
v_add_u32 v12, s34, v12
s_mov_b32 s77, 0
L_poll_pC:
buffer_load_dword v3, v12, s[12:15], 0 offen sc1
s_waitcnt vmcnt(0)
v_cmp_le_u32 vcc, 2, v3
s_add_u32 s77, s77, 1
s_cmp_eq_u64 vcc, exec
s_cbranch_scc1 L_pollok_pC
s_cmp_lt_u32 s77, 20000
s_cbranch_scc0 L_pollok_pC
s_sleep 2
s_branch L_poll_pC
L_pollok_pC:
v_and_b32 v3, 15, v1
v_lshrrev_b32 v4, 4, v1
s_lshl_b32 s36, s22, 6
v_add_u32 v5, s36, v3
s_lshl_b32 s36, s57, 6
s_lshl_b32 s35, s55, 4
s_add_u32 s36, s36, s35
v_lshlrev_b32 v6, 2, v4
v_add_u32 v6, s36, v6
v_mul_u32_u24 v7, 1152, v5
v_lshl_add_u32 v7, v6, 1, v7
v_lshlrev_b32 v8, 12, v6
v_lshl_add_u32 v8, v5, 1, v8
v_add_u32 v8, 4784128, v8
v_lshlrev_b32 v9, 3, v5
v_add_u32 v9, 2359296, v9
s_mul_i32 s36, s22, 9
s_add_u32 s36, s36, s57
s_lshl_b32 s36, s36, 2
s_add_u32 s36, s36, s55
s_mul_i32 s36, s36, 2048
s_add_u32 s36, s36, 7340032
buffer_load_dwordx4 a[0:3], v19, s[12:15], s36 offen sc1
buffer_load_dwordx4 a[4:7], v19, s[12:15], s36 offen offset:1024 sc1
s_add_u32 s36, s36, 2359296
buffer_load_dwordx4 a[8:11], v19, s[12:15], s36 offen sc1
buffer_load_dwordx4 a[12:15], v19, s[12:15], s36 offen offset:1024 sc1
s_add_u32 s36, s36, 2359296
buffer_load_dwordx4 a[16:19], v19, s[12:15], s36 offen sc1
buffer_load_dwordx4 a[20:23], v19, s[12:15], s36 offen offset:1024 sc1
s_add_u32 s36, s36, 2359296
buffer_load_dwordx4 a[24:27], v19, s[12:15], s36 offen sc1
buffer_load_dwordx4 a[28:31], v19, s[12:15], s36 offen offset:1024 sc1
s_add_u32 s36, s36, 2359296
buffer_load_dwordx4 a[32:35], v19, s[12:15], s36 offen sc1
buffer_load_dwordx4 a[36:39], v19, s[12:15], s36 offen offset:1024 sc1
s_add_u32 s36, s36, 2359296
buffer_load_dwordx4 a[40:43], v19, s[12:15], s36 offen sc1
buffer_load_dwordx4 a[44:47], v19, s[12:15], s36 offen offset:1024 sc1
s_add_u32 s36, s36, 2359296
buffer_load_dwordx4 a[48:51], v19, s[12:15], s36 offen sc1
buffer_load_dwordx4 a[52:55], v19, s[12:15], s36 offen offset:1024 sc1
s_add_u32 s36, s36, 2359296
buffer_load_dwordx4 a[56:59], v19, s[12:15], s36 offen sc1
buffer_load_dwordx4 a[60:63], v19, s[12:15], s36 offen offset:1024 sc1
s_mov_b32 s37, 0
buffer_load_dwordx2 a[64:65], v7, s[72:75], s37 offen
s_mov_b32 s37, 18432
buffer_load_dwordx2 a[66:67], v7, s[72:75], s37 offen
s_mov_b32 s37, 36864
buffer_load_dwordx2 a[68:69], v7, s[72:75], s37 offen
s_mov_b32 s37, 55296
buffer_load_dwordx2 a[70:71], v7, s[72:75], s37 offen
buffer_load_dwordx2 a[72:73], v9, s[12:15], 0 offen sc1
buffer_load_dwordx2 a[74:75], v9, s[12:15], 0 offen offset:128 sc1
buffer_load_dwordx2 a[76:77], v9, s[12:15], 0 offen offset:256 sc1
buffer_load_dwordx2 a[78:79], v9, s[12:15], 0 offen offset:384 sc1
L_stg:
s_cmp_eq_u32 s54, 0
s_cbranch_scc1 L_prea
s_waitcnt vmcnt(0)
L_prea:
s_mov_b32 s37, 0xffff0000
v_rcp_f32 v240, v233
v_rcp_f32 v241, v235
v_rcp_f32 v242, v237
v_rcp_f32 v243, v239
s_nop 0
v_mul_f32 v64, v240, v240
v_mul_f32 v65, v241, v241
v_mul_f32 v66, v242, v242
v_mul_f32 v67, v243, v243
v_lshlrev_b32 v48, 16, v208
v_and_b32 v49, s37, v208
v_lshlrev_b32 v50, 16, v209
v_and_b32 v51, s37, v209
v_sub_f32 v32, v48, v232
v_sub_f32 v33, v49, v232
v_sub_f32 v34, v50, v232
v_sub_f32 v35, v51, v232
v_cvt_pk_bf16_f32 v244, v32, v33
v_cvt_pk_bf16_f32 v245, v34, v35
v_lshlrev_b32 v32, 16, v244
v_and_b32 v33, s37, v244
v_lshlrev_b32 v34, 16, v245
v_and_b32 v35, s37, v245
v_mul_f32 v32, v32, v240
v_mul_f32 v33, v33, v240
v_mul_f32 v34, v34, v240
v_mul_f32 v35, v35, v240
v_cvt_pk_bf16_f32 v244, v32, v33
v_cvt_pk_bf16_f32 v245, v34, v35
v_lshlrev_b32 v32, 16, v244
v_and_b32 v33, s37, v244
v_lshlrev_b32 v34, 16, v245
v_and_b32 v35, s37, v245
v_lshlrev_b32 v52, 16, v210
v_and_b32 v53, s37, v210
v_lshlrev_b32 v54, 16, v211
v_and_b32 v55, s37, v211
v_sub_f32 v36, v52, v234
v_sub_f32 v37, v53, v234
v_sub_f32 v38, v54, v234
v_sub_f32 v39, v55, v234
v_cvt_pk_bf16_f32 v246, v36, v37
v_cvt_pk_bf16_f32 v247, v38, v39
v_lshlrev_b32 v36, 16, v246
v_and_b32 v37, s37, v246
v_lshlrev_b32 v38, 16, v247
v_and_b32 v39, s37, v247
v_mul_f32 v36, v36, v241
v_mul_f32 v37, v37, v241
v_mul_f32 v38, v38, v241
v_mul_f32 v39, v39, v241
v_cvt_pk_bf16_f32 v246, v36, v37
v_cvt_pk_bf16_f32 v247, v38, v39
v_lshlrev_b32 v36, 16, v246
v_and_b32 v37, s37, v246
v_lshlrev_b32 v38, 16, v247
v_and_b32 v39, s37, v247
v_lshlrev_b32 v56, 16, v212
v_and_b32 v57, s37, v212
v_lshlrev_b32 v58, 16, v213
v_and_b32 v59, s37, v213
v_sub_f32 v40, v56, v236
v_sub_f32 v41, v57, v236
v_sub_f32 v42, v58, v236
v_sub_f32 v43, v59, v236
v_cvt_pk_bf16_f32 v244, v40, v41
v_cvt_pk_bf16_f32 v245, v42, v43
v_lshlrev_b32 v40, 16, v244
v_and_b32 v41, s37, v244
v_lshlrev_b32 v42, 16, v245
v_and_b32 v43, s37, v245
v_mul_f32 v40, v40, v242
v_mul_f32 v41, v41, v242
v_mul_f32 v42, v42, v242
v_mul_f32 v43, v43, v242
v_cvt_pk_bf16_f32 v244, v40, v41
v_cvt_pk_bf16_f32 v245, v42, v43
v_lshlrev_b32 v40, 16, v244
v_and_b32 v41, s37, v244
v_lshlrev_b32 v42, 16, v245
v_and_b32 v43, s37, v245
v_lshlrev_b32 v60, 16, v214
v_and_b32 v61, s37, v214
v_lshlrev_b32 v62, 16, v215
v_and_b32 v63, s37, v215
v_sub_f32 v44, v60, v238
v_sub_f32 v45, v61, v238
v_sub_f32 v46, v62, v238
v_sub_f32 v47, v63, v238
v_cvt_pk_bf16_f32 v246, v44, v45
v_cvt_pk_bf16_f32 v247, v46, v47
v_lshlrev_b32 v44, 16, v246
v_and_b32 v45, s37, v246
v_lshlrev_b32 v46, 16, v247
v_and_b32 v47, s37, v247
v_mul_f32 v44, v44, v243
v_mul_f32 v45, v45, v243
v_mul_f32 v46, v46, v243
v_mul_f32 v47, v47, v243
v_cvt_pk_bf16_f32 v246, v44, v45
v_cvt_pk_bf16_f32 v247, v46, v47
v_lshlrev_b32 v44, 16, v246
v_and_b32 v45, s37, v246
v_lshlrev_b32 v46, 16, v247
v_and_b32 v47, s37, v247
s_cmp_eq_u32 s54, 1
s_cbranch_scc1 L_fin2
v_mov_b32 v2, 147460
s_mov_b32 s77, 0
L_lw_stg:
ds_read_b32 v3, v2
s_waitcnt lgkmcnt(0)
v_readfirstlane_b32 s34, v3
s_add_u32 s77, s77, 1
s_cmp_eq_u32 s34, 1
s_cbranch_scc1 L_lwok_stg
s_cmp_lt_u32 s77, 200000
s_cbranch_scc0 L_lwok_stg
s_sleep 1
s_branch L_lw_stg
L_lwok_stg:
s_lshl_b32 s34, s20, 11
v_add_u32 v2, s34, v19
ds_read_b128 v[128:131], v2 offset:0
ds_read_b128 v[132:135], v2 offset:1024
ds_read_b128 v[136:139], v2 offset:8192
ds_read_b128 v[140:143], v2 offset:9216
ds_read_b128 v[144:147], v2 offset:16384
ds_read_b128 v[148:151], v2 offset:17408
ds_read_b128 v[152:155], v2 offset:24576
ds_read_b128 v[156:159], v2 offset:25600
ds_read_b128 v[160:163], v2 offset:32768
ds_read_b128 v[164:167], v2 offset:33792
ds_read_b128 v[168:171], v2 offset:40960
ds_read_b128 v[172:175], v2 offset:41984
ds_read_b128 v[176:179], v2 offset:49152
ds_read_b128 v[180:183], v2 offset:50176
ds_read_b128 v[184:187], v2 offset:57344
ds_read_b128 v[188:191], v2 offset:58368
s_waitcnt lgkmcnt(0)
L_fin2:
s_mov_b32 s37, 0xffff0000
v_lshlrev_b32 v192, 16, v128
v_and_b32 v193, s37, v128
v_lshlrev_b32 v194, 16, v129
v_and_b32 v195, s37, v129
v_lshlrev_b32 v196, 16, v130
v_and_b32 v197, s37, v130
v_lshlrev_b32 v198, 16, v131
v_and_b32 v199, s37, v131
v_lshlrev_b32 v200, 16, v132
v_and_b32 v201, s37, v132
v_lshlrev_b32 v202, 16, v133
v_and_b32 v203, s37, v133
v_lshlrev_b32 v204, 16, v134
v_and_b32 v205, s37, v134
v_lshlrev_b32 v206, 16, v135
v_and_b32 v207, s37, v135
v_lshlrev_b32 v240, 16, v136
v_and_b32 v241, s37, v136
v_pk_add_f32 v[192:193], v[192:193], v[240:241]
v_lshlrev_b32 v242, 16, v137
v_and_b32 v243, s37, v137
v_pk_add_f32 v[194:195], v[194:195], v[242:243]
v_lshlrev_b32 v240, 16, v138
v_and_b32 v241, s37, v138
v_pk_add_f32 v[196:197], v[196:197], v[240:241]
v_lshlrev_b32 v242, 16, v139
v_and_b32 v243, s37, v139
v_pk_add_f32 v[198:199], v[198:199], v[242:243]
v_lshlrev_b32 v240, 16, v140
v_and_b32 v241, s37, v140
v_pk_add_f32 v[200:201], v[200:201], v[240:241]
v_lshlrev_b32 v242, 16, v141
v_and_b32 v243, s37, v141
v_pk_add_f32 v[202:203], v[202:203], v[242:243]
v_lshlrev_b32 v240, 16, v142
v_and_b32 v241, s37, v142
v_pk_add_f32 v[204:205], v[204:205], v[240:241]
v_lshlrev_b32 v242, 16, v143
v_and_b32 v243, s37, v143
v_pk_add_f32 v[206:207], v[206:207], v[242:243]
v_lshlrev_b32 v240, 16, v144
v_and_b32 v241, s37, v144
v_pk_add_f32 v[192:193], v[192:193], v[240:241]
v_lshlrev_b32 v242, 16, v145
v_and_b32 v243, s37, v145
v_pk_add_f32 v[194:195], v[194:195], v[242:243]
v_lshlrev_b32 v240, 16, v146
v_and_b32 v241, s37, v146
v_pk_add_f32 v[196:197], v[196:197], v[240:241]
v_lshlrev_b32 v242, 16, v147
v_and_b32 v243, s37, v147
v_pk_add_f32 v[198:199], v[198:199], v[242:243]
v_lshlrev_b32 v240, 16, v148
v_and_b32 v241, s37, v148
v_pk_add_f32 v[200:201], v[200:201], v[240:241]
v_lshlrev_b32 v242, 16, v149
v_and_b32 v243, s37, v149
v_pk_add_f32 v[202:203], v[202:203], v[242:243]
v_lshlrev_b32 v240, 16, v150
v_and_b32 v241, s37, v150
v_pk_add_f32 v[204:205], v[204:205], v[240:241]
v_lshlrev_b32 v242, 16, v151
v_and_b32 v243, s37, v151
v_pk_add_f32 v[206:207], v[206:207], v[242:243]
v_lshlrev_b32 v240, 16, v152
v_and_b32 v241, s37, v152
v_pk_add_f32 v[192:193], v[192:193], v[240:241]
v_lshlrev_b32 v242, 16, v153
v_and_b32 v243, s37, v153
v_pk_add_f32 v[194:195], v[194:195], v[242:243]
v_lshlrev_b32 v240, 16, v154
v_and_b32 v241, s37, v154
v_pk_add_f32 v[196:197], v[196:197], v[240:241]
v_lshlrev_b32 v242, 16, v155
v_and_b32 v243, s37, v155
v_pk_add_f32 v[198:199], v[198:199], v[242:243]
v_lshlrev_b32 v240, 16, v156
v_and_b32 v241, s37, v156
v_pk_add_f32 v[200:201], v[200:201], v[240:241]
v_lshlrev_b32 v242, 16, v157
v_and_b32 v243, s37, v157
v_pk_add_f32 v[202:203], v[202:203], v[242:243]
v_lshlrev_b32 v240, 16, v158
v_and_b32 v241, s37, v158
v_pk_add_f32 v[204:205], v[204:205], v[240:241]
v_lshlrev_b32 v242, 16, v159
v_and_b32 v243, s37, v159
v_pk_add_f32 v[206:207], v[206:207], v[242:243]
v_lshlrev_b32 v240, 16, v160
v_and_b32 v241, s37, v160
v_pk_add_f32 v[192:193], v[192:193], v[240:241]
v_lshlrev_b32 v242, 16, v161
v_and_b32 v243, s37, v161
v_pk_add_f32 v[194:195], v[194:195], v[242:243]
v_lshlrev_b32 v240, 16, v162
v_and_b32 v241, s37, v162
v_pk_add_f32 v[196:197], v[196:197], v[240:241]
v_lshlrev_b32 v242, 16, v163
v_and_b32 v243, s37, v163
v_pk_add_f32 v[198:199], v[198:199], v[242:243]
v_lshlrev_b32 v240, 16, v164
v_and_b32 v241, s37, v164
v_pk_add_f32 v[200:201], v[200:201], v[240:241]
v_lshlrev_b32 v242, 16, v165
v_and_b32 v243, s37, v165
v_pk_add_f32 v[202:203], v[202:203], v[242:243]
v_lshlrev_b32 v240, 16, v166
v_and_b32 v241, s37, v166
v_pk_add_f32 v[204:205], v[204:205], v[240:241]
v_lshlrev_b32 v242, 16, v167
v_and_b32 v243, s37, v167
v_pk_add_f32 v[206:207], v[206:207], v[242:243]
v_lshlrev_b32 v240, 16, v168
v_and_b32 v241, s37, v168
v_pk_add_f32 v[192:193], v[192:193], v[240:241]
v_lshlrev_b32 v242, 16, v169
v_and_b32 v243, s37, v169
v_pk_add_f32 v[194:195], v[194:195], v[242:243]
v_lshlrev_b32 v240, 16, v170
v_and_b32 v241, s37, v170
v_pk_add_f32 v[196:197], v[196:197], v[240:241]
v_lshlrev_b32 v242, 16, v171
v_and_b32 v243, s37, v171
v_pk_add_f32 v[198:199], v[198:199], v[242:243]
v_lshlrev_b32 v240, 16, v172
v_and_b32 v241, s37, v172
v_pk_add_f32 v[200:201], v[200:201], v[240:241]
v_lshlrev_b32 v242, 16, v173
v_and_b32 v243, s37, v173
v_pk_add_f32 v[202:203], v[202:203], v[242:243]
v_lshlrev_b32 v240, 16, v174
v_and_b32 v241, s37, v174
v_pk_add_f32 v[204:205], v[204:205], v[240:241]
v_lshlrev_b32 v242, 16, v175
v_and_b32 v243, s37, v175
v_pk_add_f32 v[206:207], v[206:207], v[242:243]
v_lshlrev_b32 v240, 16, v176
v_and_b32 v241, s37, v176
v_pk_add_f32 v[192:193], v[192:193], v[240:241]
v_lshlrev_b32 v242, 16, v177
v_and_b32 v243, s37, v177
v_pk_add_f32 v[194:195], v[194:195], v[242:243]
v_lshlrev_b32 v240, 16, v178
v_and_b32 v241, s37, v178
v_pk_add_f32 v[196:197], v[196:197], v[240:241]
v_lshlrev_b32 v242, 16, v179
v_and_b32 v243, s37, v179
v_pk_add_f32 v[198:199], v[198:199], v[242:243]
v_lshlrev_b32 v240, 16, v180
v_and_b32 v241, s37, v180
v_pk_add_f32 v[200:201], v[200:201], v[240:241]
v_lshlrev_b32 v242, 16, v181
v_and_b32 v243, s37, v181
v_pk_add_f32 v[202:203], v[202:203], v[242:243]
v_lshlrev_b32 v240, 16, v182
v_and_b32 v241, s37, v182
v_pk_add_f32 v[204:205], v[204:205], v[240:241]
v_lshlrev_b32 v242, 16, v183
v_and_b32 v243, s37, v183
v_pk_add_f32 v[206:207], v[206:207], v[242:243]
v_lshlrev_b32 v240, 16, v184
v_and_b32 v241, s37, v184
v_pk_add_f32 v[192:193], v[192:193], v[240:241]
v_lshlrev_b32 v242, 16, v185
v_and_b32 v243, s37, v185
v_pk_add_f32 v[194:195], v[194:195], v[242:243]
v_lshlrev_b32 v240, 16, v186
v_and_b32 v241, s37, v186
v_pk_add_f32 v[196:197], v[196:197], v[240:241]
v_lshlrev_b32 v242, 16, v187
v_and_b32 v243, s37, v187
v_pk_add_f32 v[198:199], v[198:199], v[242:243]
v_lshlrev_b32 v240, 16, v188
v_and_b32 v241, s37, v188
v_pk_add_f32 v[200:201], v[200:201], v[240:241]
v_lshlrev_b32 v242, 16, v189
v_and_b32 v243, s37, v189
v_pk_add_f32 v[202:203], v[202:203], v[242:243]
v_lshlrev_b32 v240, 16, v190
v_and_b32 v241, s37, v190
v_pk_add_f32 v[204:205], v[204:205], v[240:241]
v_lshlrev_b32 v242, 16, v191
v_and_b32 v243, s37, v191
v_pk_add_f32 v[206:207], v[206:207], v[242:243]
s_mov_b32 s37, 0xffff0000
v_mul_f32 v68, v192, v64
v_mul_f32 v69, v193, v64
v_mul_f32 v70, v194, v64
v_mul_f32 v71, v195, v64
v_cvt_pk_bf16_f32 v244, v68, v69
v_cvt_pk_bf16_f32 v245, v70, v71
v_lshlrev_b32 v68, 16, v244
v_and_b32 v69, s37, v244
v_lshlrev_b32 v70, 16, v245
v_and_b32 v71, s37, v245
v_mul_f32 v72, v196, v65
v_mul_f32 v73, v197, v65
v_mul_f32 v74, v198, v65
v_mul_f32 v75, v199, v65
v_cvt_pk_bf16_f32 v246, v72, v73
v_cvt_pk_bf16_f32 v247, v74, v75
v_lshlrev_b32 v72, 16, v246
v_and_b32 v73, s37, v246
v_lshlrev_b32 v74, 16, v247
v_and_b32 v75, s37, v247
v_mul_f32 v76, v200, v66
v_mul_f32 v77, v201, v66
v_mul_f32 v78, v202, v66
v_mul_f32 v79, v203, v66
v_cvt_pk_bf16_f32 v244, v76, v77
v_cvt_pk_bf16_f32 v245, v78, v79
v_lshlrev_b32 v76, 16, v244
v_and_b32 v77, s37, v244
v_lshlrev_b32 v78, 16, v245
v_and_b32 v79, s37, v245
v_mul_f32 v80, v204, v67
v_mul_f32 v81, v205, v67
v_mul_f32 v82, v206, v67
v_mul_f32 v83, v207, v67
v_cvt_pk_bf16_f32 v246, v80, v81
v_cvt_pk_bf16_f32 v247, v82, v83
v_lshlrev_b32 v80, 16, v246
v_and_b32 v81, s37, v246
v_lshlrev_b32 v82, 16, v247
v_and_b32 v83, s37, v247
s_cmp_lg_u32 s54, 0
s_cbranch_scc1 L_zbar
v_accvgpr_write_b32 a80, v32
v_accvgpr_write_b32 a81, v33
v_accvgpr_write_b32 a82, v34
v_accvgpr_write_b32 a83, v35
v_accvgpr_write_b32 a84, v36
v_accvgpr_write_b32 a85, v37
v_accvgpr_write_b32 a86, v38
v_accvgpr_write_b32 a87, v39
v_accvgpr_write_b32 a88, v40
v_accvgpr_write_b32 a89, v41
v_accvgpr_write_b32 a90, v42
v_accvgpr_write_b32 a91, v43
v_accvgpr_write_b32 a92, v44
v_accvgpr_write_b32 a93, v45
v_accvgpr_write_b32 a94, v46
v_accvgpr_write_b32 a95, v47
v_accvgpr_write_b32 a96, v48
v_accvgpr_write_b32 a97, v49
v_accvgpr_write_b32 a98, v50
v_accvgpr_write_b32 a99, v51
v_accvgpr_write_b32 a100, v52
v_accvgpr_write_b32 a101, v53
v_accvgpr_write_b32 a102, v54
v_accvgpr_write_b32 a103, v55
v_accvgpr_write_b32 a104, v56
v_accvgpr_write_b32 a105, v57
v_accvgpr_write_b32 a106, v58
v_accvgpr_write_b32 a107, v59
v_accvgpr_write_b32 a108, v60
v_accvgpr_write_b32 a109, v61
v_accvgpr_write_b32 a110, v62
v_accvgpr_write_b32 a111, v63
v_accvgpr_write_b32 a112, v64
v_accvgpr_write_b32 a113, v65
v_accvgpr_write_b32 a114, v66
v_accvgpr_write_b32 a115, v67
v_accvgpr_write_b32 a116, v68
v_accvgpr_write_b32 a117, v69
v_accvgpr_write_b32 a118, v70
v_accvgpr_write_b32 a119, v71
v_accvgpr_write_b32 a120, v72
v_accvgpr_write_b32 a121, v73
v_accvgpr_write_b32 a122, v74
v_accvgpr_write_b32 a123, v75
v_accvgpr_write_b32 a124, v76
v_accvgpr_write_b32 a125, v77
v_accvgpr_write_b32 a126, v78
v_accvgpr_write_b32 a127, v79
v_accvgpr_write_b32 a128, v80
v_accvgpr_write_b32 a129, v81
v_accvgpr_write_b32 a130, v82
v_accvgpr_write_b32 a131, v83
s_waitcnt vmcnt(0)
v_accvgpr_read_b32 v128, a0
v_accvgpr_read_b32 v129, a1
v_accvgpr_read_b32 v130, a2
v_accvgpr_read_b32 v131, a3
v_accvgpr_read_b32 v132, a4
v_accvgpr_read_b32 v133, a5
v_accvgpr_read_b32 v134, a6
v_accvgpr_read_b32 v135, a7
v_accvgpr_read_b32 v136, a8
v_accvgpr_read_b32 v137, a9
v_accvgpr_read_b32 v138, a10
v_accvgpr_read_b32 v139, a11
v_accvgpr_read_b32 v140, a12
v_accvgpr_read_b32 v141, a13
v_accvgpr_read_b32 v142, a14
v_accvgpr_read_b32 v143, a15
v_accvgpr_read_b32 v144, a16
v_accvgpr_read_b32 v145, a17
v_accvgpr_read_b32 v146, a18
v_accvgpr_read_b32 v147, a19
v_accvgpr_read_b32 v148, a20
v_accvgpr_read_b32 v149, a21
v_accvgpr_read_b32 v150, a22
v_accvgpr_read_b32 v151, a23
v_accvgpr_read_b32 v152, a24
v_accvgpr_read_b32 v153, a25
v_accvgpr_read_b32 v154, a26
v_accvgpr_read_b32 v155, a27
v_accvgpr_read_b32 v156, a28
v_accvgpr_read_b32 v157, a29
v_accvgpr_read_b32 v158, a30
v_accvgpr_read_b32 v159, a31
v_accvgpr_read_b32 v160, a32
v_accvgpr_read_b32 v161, a33
v_accvgpr_read_b32 v162, a34
v_accvgpr_read_b32 v163, a35
v_accvgpr_read_b32 v164, a36
v_accvgpr_read_b32 v165, a37
v_accvgpr_read_b32 v166, a38
v_accvgpr_read_b32 v167, a39
v_accvgpr_read_b32 v168, a40
v_accvgpr_read_b32 v169, a41
v_accvgpr_read_b32 v170, a42
v_accvgpr_read_b32 v171, a43
v_accvgpr_read_b32 v172, a44
v_accvgpr_read_b32 v173, a45
v_accvgpr_read_b32 v174, a46
v_accvgpr_read_b32 v175, a47
v_accvgpr_read_b32 v176, a48
v_accvgpr_read_b32 v177, a49
v_accvgpr_read_b32 v178, a50
v_accvgpr_read_b32 v179, a51
v_accvgpr_read_b32 v180, a52
v_accvgpr_read_b32 v181, a53
v_accvgpr_read_b32 v182, a54
v_accvgpr_read_b32 v183, a55
v_accvgpr_read_b32 v184, a56
v_accvgpr_read_b32 v185, a57
v_accvgpr_read_b32 v186, a58
v_accvgpr_read_b32 v187, a59
v_accvgpr_read_b32 v188, a60
v_accvgpr_read_b32 v189, a61
v_accvgpr_read_b32 v190, a62
v_accvgpr_read_b32 v191, a63
v_accvgpr_read_b32 v208, a64
v_accvgpr_read_b32 v209, a65
v_accvgpr_read_b32 v210, a66
v_accvgpr_read_b32 v211, a67
v_accvgpr_read_b32 v212, a68
v_accvgpr_read_b32 v213, a69
v_accvgpr_read_b32 v214, a70
v_accvgpr_read_b32 v215, a71
v_accvgpr_read_b32 v232, a72
v_accvgpr_read_b32 v233, a73
v_accvgpr_read_b32 v234, a74
v_accvgpr_read_b32 v235, a75
v_accvgpr_read_b32 v236, a76
v_accvgpr_read_b32 v237, a77
v_accvgpr_read_b32 v238, a78
v_accvgpr_read_b32 v239, a79
s_mov_b32 s54, 1
s_branch L_prea
L_zbar:
s_cmp_lt_u32 s70, 576
s_cbranch_scc1 L_zgo
v_mov_b32 v2, 147456
s_mov_b32 s77, 0
L_zwait:
ds_read_b32 v3, v2
s_waitcnt lgkmcnt(0)
v_readfirstlane_b32 s34, v3
s_add_u32 s77, s77, 1
s_cmp_eq_u32 s34, 1
s_cbranch_scc1 L_zgo
s_cmp_lt_u32 s77, 100000
s_cbranch_scc0 L_zgo
s_sleep 2
s_branch L_zwait
L_zgo:
s_mov_b32 s77, 0
L_zre_A:
s_mov_b32 s37, 0
buffer_load_ushort v216, v8, s[12:15], s37 offen sc1
s_mov_b32 s37, 4096
buffer_load_ushort v217, v8, s[12:15], s37 offen sc1
s_mov_b32 s37, 8192
buffer_load_ushort v218, v8, s[12:15], s37 offen sc1
s_mov_b32 s37, 12288
buffer_load_ushort v219, v8, s[12:15], s37 offen sc1
s_mov_b32 s37, 0
buffer_load_ushort v220, v8, s[12:15], s37 offen offset:32 sc1
s_mov_b32 s37, 4096
buffer_load_ushort v221, v8, s[12:15], s37 offen offset:32 sc1
s_mov_b32 s37, 8192
buffer_load_ushort v222, v8, s[12:15], s37 offen offset:32 sc1
s_mov_b32 s37, 12288
buffer_load_ushort v223, v8, s[12:15], s37 offen offset:32 sc1
s_mov_b32 s37, 0
buffer_load_ushort v224, v8, s[12:15], s37 offen offset:64 sc1
s_mov_b32 s37, 4096
buffer_load_ushort v225, v8, s[12:15], s37 offen offset:64 sc1
s_mov_b32 s37, 8192
buffer_load_ushort v226, v8, s[12:15], s37 offen offset:64 sc1
s_mov_b32 s37, 12288
buffer_load_ushort v227, v8, s[12:15], s37 offen offset:64 sc1
s_mov_b32 s37, 0
buffer_load_ushort v228, v8, s[12:15], s37 offen offset:96 sc1
s_mov_b32 s37, 4096
buffer_load_ushort v229, v8, s[12:15], s37 offen offset:96 sc1
s_mov_b32 s37, 8192
buffer_load_ushort v230, v8, s[12:15], s37 offen offset:96 sc1
s_mov_b32 s37, 12288
buffer_load_ushort v231, v8, s[12:15], s37 offen offset:96 sc1
s_cmp_lg_u32 s54, 1
s_cbranch_scc1 L_z1_A
s_mov_b32 s37, 0
buffer_load_ushort v84, v101, s[12:15], s37 offen sc1
s_mov_b32 s37, 4096
buffer_load_ushort v85, v101, s[12:15], s37 offen sc1
s_mov_b32 s37, 8192
buffer_load_ushort v86, v101, s[12:15], s37 offen sc1
s_mov_b32 s37, 12288
buffer_load_ushort v87, v101, s[12:15], s37 offen sc1
s_mov_b32 s37, 0
buffer_load_ushort v88, v101, s[12:15], s37 offen offset:32 sc1
s_mov_b32 s37, 4096
buffer_load_ushort v89, v101, s[12:15], s37 offen offset:32 sc1
s_mov_b32 s37, 8192
buffer_load_ushort v90, v101, s[12:15], s37 offen offset:32 sc1
s_mov_b32 s37, 12288
buffer_load_ushort v91, v101, s[12:15], s37 offen offset:32 sc1
s_mov_b32 s37, 0
buffer_load_ushort v92, v101, s[12:15], s37 offen offset:64 sc1
s_mov_b32 s37, 4096
buffer_load_ushort v93, v101, s[12:15], s37 offen offset:64 sc1
s_mov_b32 s37, 8192
buffer_load_ushort v94, v101, s[12:15], s37 offen offset:64 sc1
s_mov_b32 s37, 12288
buffer_load_ushort v95, v101, s[12:15], s37 offen offset:64 sc1
s_mov_b32 s37, 0
buffer_load_ushort v96, v101, s[12:15], s37 offen offset:96 sc1
s_mov_b32 s37, 4096
buffer_load_ushort v97, v101, s[12:15], s37 offen offset:96 sc1
s_mov_b32 s37, 8192
buffer_load_ushort v98, v101, s[12:15], s37 offen offset:96 sc1
s_mov_b32 s37, 12288
buffer_load_ushort v99, v101, s[12:15], s37 offen offset:96 sc1
s_waitcnt vmcnt(0)
v_max3_u32 v2, v84, v85, v86
v_max3_u32 v2, v2, v87, v88
v_max3_u32 v2, v2, v89, v90
v_max3_u32 v2, v2, v91, v92
v_max3_u32 v2, v2, v93, v94
v_max3_u32 v2, v2, v95, v96
v_max3_u32 v2, v2, v97, v98
v_max_u32 v3, v2, v99
s_branch L_z2_A
L_z1_A:
s_waitcnt vmcnt(0)
v_mov_b32 v3, 0
L_z2_A:
v_max3_u32 v2, v216, v217, v218
v_max3_u32 v2, v2, v219, v220
v_max3_u32 v2, v2, v221, v222
v_max3_u32 v2, v2, v223, v224
v_max3_u32 v2, v2, v225, v226
v_max3_u32 v2, v2, v227, v228
v_max3_u32 v2, v2, v229, v230
v_max3_u32 v2, v2, v231, v3
v_cmp_eq_u32 vcc, 0xffff, v2
s_add_u32 s77, s77, 1
s_nop 0
s_cmp_eq_u64 vcc, 0
s_cbranch_scc1 L_zok_A
s_cmp_lt_u32 s77, 5000
s_cbranch_scc0 L_zok_A
s_sleep 2
s_branch L_zre_A
L_zok_A:
L_comb:
s_mov_b32 s37, 0xffff0000
v_lshlrev_b32 v176, 16, v216
v_lshlrev_b32 v177, 16, v217
v_lshlrev_b32 v178, 16, v218
v_lshlrev_b32 v179, 16, v219
v_mul_f32 v176, v176, v32
v_mul_f32 v177, v177, v33
v_mul_f32 v178, v178, v34
v_mul_f32 v179, v179, v35
v_cvt_pk_bf16_f32 v180, v176, v177
v_cvt_pk_bf16_f32 v181, v178, v179
v_lshlrev_b32 v176, 16, v180
v_and_b32 v177, s37, v180
v_lshlrev_b32 v178, 16, v181
v_and_b32 v179, s37, v181
v_add_f32 v176, v176, v48
v_add_f32 v177, v177, v49
v_add_f32 v178, v178, v50
v_add_f32 v179, v179, v51
v_cvt_pk_bf16_f32 v180, v176, v177
v_cvt_pk_bf16_f32 v181, v178, v179
v_lshlrev_b32 v176, 16, v180
v_and_b32 v177, s37, v180
v_lshlrev_b32 v178, 16, v181
v_and_b32 v179, s37, v181
v_add_f32 v176, v176, v68
v_add_f32 v177, v177, v69
v_add_f32 v178, v178, v70
v_add_f32 v179, v179, v71
v_cvt_pk_bf16_f32 v182, v176, v177
v_cvt_pk_bf16_f32 v183, v178, v179
s_mov_b32 s36, 0
buffer_store_dwordx2 v[182:183], v7, s[64:67], s36 offen
v_lshlrev_b32 v184, 16, v220
v_lshlrev_b32 v185, 16, v221
v_lshlrev_b32 v186, 16, v222
v_lshlrev_b32 v187, 16, v223
v_mul_f32 v184, v184, v36
v_mul_f32 v185, v185, v37
v_mul_f32 v186, v186, v38
v_mul_f32 v187, v187, v39
v_cvt_pk_bf16_f32 v188, v184, v185
v_cvt_pk_bf16_f32 v189, v186, v187
v_lshlrev_b32 v184, 16, v188
v_and_b32 v185, s37, v188
v_lshlrev_b32 v186, 16, v189
v_and_b32 v187, s37, v189
v_add_f32 v184, v184, v52
v_add_f32 v185, v185, v53
v_add_f32 v186, v186, v54
v_add_f32 v187, v187, v55
v_cvt_pk_bf16_f32 v188, v184, v185
v_cvt_pk_bf16_f32 v189, v186, v187
v_lshlrev_b32 v184, 16, v188
v_and_b32 v185, s37, v188
v_lshlrev_b32 v186, 16, v189
v_and_b32 v187, s37, v189
v_add_f32 v184, v184, v72
v_add_f32 v185, v185, v73
v_add_f32 v186, v186, v74
v_add_f32 v187, v187, v75
v_cvt_pk_bf16_f32 v190, v184, v185
v_cvt_pk_bf16_f32 v191, v186, v187
s_mov_b32 s36, 18432
buffer_store_dwordx2 v[190:191], v7, s[64:67], s36 offen
v_lshlrev_b32 v176, 16, v224
v_lshlrev_b32 v177, 16, v225
v_lshlrev_b32 v178, 16, v226
v_lshlrev_b32 v179, 16, v227
v_mul_f32 v176, v176, v40
v_mul_f32 v177, v177, v41
v_mul_f32 v178, v178, v42
v_mul_f32 v179, v179, v43
v_cvt_pk_bf16_f32 v180, v176, v177
v_cvt_pk_bf16_f32 v181, v178, v179
v_lshlrev_b32 v176, 16, v180
v_and_b32 v177, s37, v180
v_lshlrev_b32 v178, 16, v181
v_and_b32 v179, s37, v181
v_add_f32 v176, v176, v56
v_add_f32 v177, v177, v57
v_add_f32 v178, v178, v58
v_add_f32 v179, v179, v59
v_cvt_pk_bf16_f32 v180, v176, v177
v_cvt_pk_bf16_f32 v181, v178, v179
v_lshlrev_b32 v176, 16, v180
v_and_b32 v177, s37, v180
v_lshlrev_b32 v178, 16, v181
v_and_b32 v179, s37, v181
v_add_f32 v176, v176, v76
v_add_f32 v177, v177, v77
v_add_f32 v178, v178, v78
v_add_f32 v179, v179, v79
v_cvt_pk_bf16_f32 v182, v176, v177
v_cvt_pk_bf16_f32 v183, v178, v179
s_mov_b32 s36, 36864
buffer_store_dwordx2 v[182:183], v7, s[64:67], s36 offen
v_lshlrev_b32 v184, 16, v228
v_lshlrev_b32 v185, 16, v229
v_lshlrev_b32 v186, 16, v230
v_lshlrev_b32 v187, 16, v231
v_mul_f32 v184, v184, v44
v_mul_f32 v185, v185, v45
v_mul_f32 v186, v186, v46
v_mul_f32 v187, v187, v47
v_cvt_pk_bf16_f32 v188, v184, v185
v_cvt_pk_bf16_f32 v189, v186, v187
v_lshlrev_b32 v184, 16, v188
v_and_b32 v185, s37, v188
v_lshlrev_b32 v186, 16, v189
v_and_b32 v187, s37, v189
v_add_f32 v184, v184, v60
v_add_f32 v185, v185, v61
v_add_f32 v186, v186, v62
v_add_f32 v187, v187, v63
v_cvt_pk_bf16_f32 v188, v184, v185
v_cvt_pk_bf16_f32 v189, v186, v187
v_lshlrev_b32 v184, 16, v188
v_and_b32 v185, s37, v188
v_lshlrev_b32 v186, 16, v189
v_and_b32 v187, s37, v189
v_add_f32 v184, v184, v80
v_add_f32 v185, v185, v81
v_add_f32 v186, v186, v82
v_add_f32 v187, v187, v83
v_cvt_pk_bf16_f32 v190, v184, v185
v_cvt_pk_bf16_f32 v191, v186, v187
s_mov_b32 s36, 55296
buffer_store_dwordx2 v[190:191], v7, s[64:67], s36 offen
s_cmp_lg_u32 s54, 1
s_cbranch_scc1 L_final_done
s_nop 1
v_accvgpr_read_b32 v32, a80
v_accvgpr_read_b32 v33, a81
v_accvgpr_read_b32 v34, a82
v_accvgpr_read_b32 v35, a83
v_accvgpr_read_b32 v36, a84
v_accvgpr_read_b32 v37, a85
v_accvgpr_read_b32 v38, a86
v_accvgpr_read_b32 v39, a87
v_accvgpr_read_b32 v40, a88
v_accvgpr_read_b32 v41, a89
v_accvgpr_read_b32 v42, a90
v_accvgpr_read_b32 v43, a91
v_accvgpr_read_b32 v44, a92
v_accvgpr_read_b32 v45, a93
v_accvgpr_read_b32 v46, a94
v_accvgpr_read_b32 v47, a95
v_accvgpr_read_b32 v48, a96
v_accvgpr_read_b32 v49, a97
v_accvgpr_read_b32 v50, a98
v_accvgpr_read_b32 v51, a99
v_accvgpr_read_b32 v52, a100
v_accvgpr_read_b32 v53, a101
v_accvgpr_read_b32 v54, a102
v_accvgpr_read_b32 v55, a103
v_accvgpr_read_b32 v56, a104
v_accvgpr_read_b32 v57, a105
v_accvgpr_read_b32 v58, a106
v_accvgpr_read_b32 v59, a107
v_accvgpr_read_b32 v60, a108
v_accvgpr_read_b32 v61, a109
v_accvgpr_read_b32 v62, a110
v_accvgpr_read_b32 v63, a111
v_accvgpr_read_b32 v64, a112
v_accvgpr_read_b32 v65, a113
v_accvgpr_read_b32 v66, a114
v_accvgpr_read_b32 v67, a115
v_accvgpr_read_b32 v68, a116
v_accvgpr_read_b32 v69, a117
v_accvgpr_read_b32 v70, a118
v_accvgpr_read_b32 v71, a119
v_accvgpr_read_b32 v72, a120
v_accvgpr_read_b32 v73, a121
v_accvgpr_read_b32 v74, a122
v_accvgpr_read_b32 v75, a123
v_accvgpr_read_b32 v76, a124
v_accvgpr_read_b32 v77, a125
v_accvgpr_read_b32 v78, a126
v_accvgpr_read_b32 v79, a127
v_accvgpr_read_b32 v80, a128
v_accvgpr_read_b32 v81, a129
v_accvgpr_read_b32 v82, a130
v_accvgpr_read_b32 v83, a131
v_mov_b32 v7, v100
v_mov_b32 v8, v101
v_mov_b32 v216, v84
v_mov_b32 v217, v85
v_mov_b32 v218, v86
v_mov_b32 v219, v87
v_mov_b32 v220, v88
v_mov_b32 v221, v89
v_mov_b32 v222, v90
v_mov_b32 v223, v91
v_mov_b32 v224, v92
v_mov_b32 v225, v93
v_mov_b32 v226, v94
v_mov_b32 v227, v95
v_mov_b32 v228, v96
v_mov_b32 v229, v97
v_mov_b32 v230, v98
v_mov_b32 v231, v99
s_mov_b32 s54, 2
s_branch L_comb
L_final_done:
L_done:
s_endpgm
.section .rodata,"a"
.p2align 6
.amdhsa_kernel parallel_sum__ssm_conv_h3__glu_gated_geglu__prompt_kernel
  .amdhsa_next_free_vgpr 512
  .amdhsa_next_free_sgpr 100
  .amdhsa_accum_offset 256
  .amdhsa_group_segment_fixed_size 0
  .amdhsa_kernarg_size 104
  .amdhsa_user_sgpr_count 2
  .amdhsa_user_sgpr_kernarg_segment_ptr 1
  .amdhsa_system_sgpr_workgroup_id_x 1
  .amdhsa_float_denorm_mode_32 3
.end_amdhsa_kernel
```
